```python
import torch

def _softmax(x, axis=-1):
    return torch.softmax(x, dim=axis)
def _gelu(x):
    return torch.nn.functional.gelu(x, approximate="tanh")
def _silu(x):
    return torch.nn.functional.silu(x)
def _sigmoid(x):
    return torch.sigmoid(x)
def _layernorm(x, axis=-1, eps=1e-5):
    m = x.mean(dim=axis, keepdim=True)
    v = x.var(dim=axis, keepdim=True, unbiased=False)
    return (x - m) / torch.sqrt(v + eps)
def _scatter_add(tgt, idx, src, axis=0):
    return tgt.clone().index_add_(axis, idx, src)
def _segment_sum(src, seg, n):
    out = torch.zeros((n,) + src.shape[1:], dtype=src.dtype)
    return out.index_add_(0, seg, src)
def _pad(x, pw):
    flat = tuple(v for pair in reversed(pw) for v in pair)
    return torch.nn.functional.pad(x, flat)

kernel_name = 'gated_mix__ssm_conv_s5__softmax_full_mha__prompt'

def setup_inputs():

    _w = (lambda a: (lambda t: t.to(torch.bfloat16) if t.is_floating_point() else t)(torch.as_tensor(a)))
    def _A_setup():
        B, S, D = 1, 2048, 512
        P = D
        Lambda_re = -0.5 * (lambda _x: torch.exp(torch.as_tensor(_x)))((lambda *s: torch.randn(*s, dtype=torch.bfloat16) * 0.4)(P))
        Lambda_im = (lambda *s: torch.randn(*s, dtype=torch.bfloat16) * 0.8)(P) * 1.0
        B_re = (lambda *s: torch.randn(*s, dtype=torch.bfloat16) * 0.8)(P, D) * (D ** -0.5)
        B_im = (lambda *s: torch.randn(*s, dtype=torch.bfloat16) * 0.8)(P, D) * (D ** -0.5)
        C_re = (lambda *s: torch.randn(*s, dtype=torch.bfloat16) * 0.8)(D, P) * (P ** -0.5)
        C_im = (lambda *s: torch.randn(*s, dtype=torch.bfloat16) * 0.8)(D, P) * (P ** -0.5)
        log_dt = (lambda *s: torch.randn(*s, dtype=torch.bfloat16) * 0.4)(P) * 0.3 - 2.0
        Dskip = (lambda *s: torch.randn(*s, dtype=torch.bfloat16) * 0.1)(D)
        return {
            "x": _w((lambda *s: torch.randn(*s, dtype=torch.bfloat16) * 0.05)(B, S, D)),
            "Lambda_re": _w(Lambda_re),
            "Lambda_im": _w(Lambda_im),
            "B_re": _w(B_re),
            "B_im": _w(B_im),
            "C_re": _w(C_re),
            "C_im": _w(C_im),
            "log_dt": _w(log_dt),
            "Dskip": _w(Dskip),
        }
    _A_in = _A_setup()

    def _B_setup():
        B, S, D = 1, 2048, 512
        return {
            "x": _w((lambda *s: torch.randn(*s, dtype=torch.bfloat16) * 0.05)(B, S, D)),
            "wqkv": _w((lambda *s: torch.randn(*s, dtype=torch.bfloat16) * 0.8)(D, 3 * D)),
            "wo": _w((lambda *s: torch.randn(*s, dtype=torch.bfloat16) * 0.05)(D, D)),
        }
    _B_in = _B_setup()

    return {
        "A_x": _A_in["x"],
        "A_Lambda_re": _A_in["Lambda_re"],
        "A_Lambda_im": _A_in["Lambda_im"],
        "A_B_re": _A_in["B_re"],
        "A_B_im": _A_in["B_im"],
        "A_C_re": _A_in["C_re"],
        "A_C_im": _A_in["C_im"],
        "A_log_dt": _A_in["log_dt"],
        "A_Dskip": _A_in["Dskip"],
        "B_x": _B_in["x"],
        "B_wqkv": _B_in["wqkv"],
        "B_wo": _B_in["wo"],
        "gate_w": _w((lambda *s: torch.randn(*s, dtype=torch.bfloat16) * 0.05)(512) * 16.0),
    }

def reference(A_x, A_Lambda_re, A_Lambda_im, A_B_re, A_B_im, A_C_re, A_C_im, A_log_dt, A_Dskip, B_x, B_wqkv, B_wo, gate_w):
    def _A_ref(x, Lambda_re, Lambda_im, B_re, B_im, C_re, C_im, log_dt, Dskip):
        Bsz, L, H = x.shape
        Lam = Lambda_re + 1j * Lambda_im
        Bmat = B_re + 1j * B_im
        Cmat = C_re + 1j * C_im
        dt = torch.exp(log_dt)
        Lam_bar = torch.exp(dt * Lam)
        B_bar = ((Lam_bar - 1.0) / Lam)[:, None] * Bmat
        Bu = torch.einsum("bld,pd->blp", x + 0j, B_bar)
        h = torch.zeros_like(Bu[:, 0, :])
        hs = []
        for t in range(L):
            h = Lam_bar[None, :] * h + Bu[:, t, :]
            hs.append(h)
        hseq = torch.stack(hs, 1)
        y = 2.0 * torch.einsum("blp,dp->bld", hseq, Cmat).real + x * Dskip[None, None, :]
        return y

    def _B_ref(x, wqkv, wo):
        B, S, D = x.shape
        H = 32; Dh = D // H
        qkv = (lambda x, *d: x.permute(*d))((x @ wqkv).reshape(B, S, 3, H, Dh), 2, 0, 3, 1, 4)
        q, k, v = qkv[0], qkv[1], qkv[2]
        scale = Dh ** -0.5
        scores = torch.einsum("bhqd,bhkd->bhqk", q, k) * scale
        p = _softmax(scores, axis=-1)
        o = torch.einsum("bhqk,bhkd->bhqd", p, v)
        return (lambda x, *d: x.permute(*d))(o, 0, 2, 1, 3).reshape(B, S, D) @ wo

    x = A_x
    g = _sigmoid((x * gate_w).sum(-1, keepdims=True))
    a = _A_ref(x, A_Lambda_re, A_Lambda_im, A_B_re, A_B_im, A_C_re, A_C_im, A_log_dt, A_Dskip)
    b = _B_ref(x, B_wqkv, B_wo)
    return g * a + (1 - g) * b
```

```asm
; @launch grid=(256,1,1) block=(512,1,1) lds=162048
.amdgcn_target "amdgcn-amd-amdhsa--gfx950"
.text
.globl gated_mix__ssm_conv_s5__softmax_full_mha__prompt_kernel
.p2align 8
.type gated_mix__ssm_conv_s5__softmax_full_mha__prompt_kernel,@function
gated_mix__ssm_conv_s5__softmax_full_mha__prompt_kernel:
    s_cmp_ge_u32 s2, 256
    s_cbranch_scc1 L_end
    s_load_dwordx16 s[40:55], s[0:1], 0
    s_load_dwordx16 s[56:71], s[0:1], 64
    v_lshrrev_b32 v1, 6, v0
    v_and_b32 v0, 63, v0
    s_and_b32 s72, s2, 7
    v_readfirstlane_b32 s3, v1
    s_lshr_b32 s73, s2, 3
    s_lshr_b32 s74, s72, 1
    s_lshl_b32 s74, s74, 2
    s_and_b32 s75, s73, 3
    s_add_u32 s34, s74, s75
    s_and_b32 s74, s72, 1
    s_lshl_b32 s74, s74, 3
    s_lshr_b32 s39, s73, 2
    s_add_u32 s35, s74, s39
    s_lshl_b32 s74, s72, 2
    s_add_u32 s38, s74, s75
    s_lshr_b32 s75, s73, 3
    s_add_u32 s36, s74, s75
    s_and_b32 s37, s73, 7
    s_and_b32 s4, s3, 3
    s_lshr_b32 s5, s3, 2
    v_lshrrev_b32 v1, 5, v0
    v_and_b32 v2, 31, v0
    v_lshlrev_b32 v3, 4, v0
    s_mul_i32 s6, s4, 12288
    s_lshl_b32 s7, s34, 2
    s_add_u32 s7, s7, s4
    s_cmp_eq_u32 s5, 0
    s_cbranch_scc0 L_G1
    s_lshl_b32 s72, s34, 7
    s_and_b32 s73, s35, 7
    s_lshl_b32 s73, s73, 4
    s_add_u32 s72, s72, s73
    s_and_b32 s73, s35, 8
    s_add_u32 s72, s72, s73
    s_lshl_b32 s73, s4, 1
    s_add_u32 s72, s72, s73
    v_add_u32 v200, s72, v1
    v_lshlrev_b32 v201, 5, v2
    v_lshl_add_u32 v202, v200, 10, v201
    v_lshlrev_b32 v228, 10, v2
    v_lshl_add_u32 v228, v1, 4, v228
    v_lshlrev_b32 v229, 1, v2
    v_lshl_add_u32 v229, v1, 12, v229
    v_add_u32 v230, 8192, v229
    s_lshl_b32 s72, s35, 15
    s_lshl_b32 s73, s7, 5
    s_and_b32 s73, s73, 1023
    s_add_u32 s72, s72, s73
    s_lshr_b32 s73, s7, 1
    s_lshl_b32 s73, s73, 14
    s_lshl_b32 s74, s35, 6
    s_add_u32 s73, s73, s74
    s_waitcnt lgkmcnt(0)
    s_mov_b32 s8, s40
    s_mov_b32 s9, s41
    s_mov_b32 s10, 0x200000
    s_mov_b32 s11, 0x00020000
    s_mov_b32 s12, s70
    s_mov_b32 s13, s71
    s_mov_b32 s14, 0x1400000
    s_mov_b32 s15, 0x00020000
    s_mov_b32 s24, s64
    s_mov_b32 s25, s65
    s_mov_b32 s26, 0x400
    s_mov_b32 s27, 0x00020000
    s_cmp_lt_u32 s34, 8
    s_cselect_b32 s20, s50, s52
    s_cselect_b32 s21, s51, s53
    s_mov_b32 s22, 524288
    s_mov_b32 s23, 0x00020000
    s_mov_b32 s16, s62
    s_mov_b32 s17, s63
    s_mov_b32 s18, 0x80000
    s_mov_b32 s19, 0x00020000
    s_mov_b32 s64, s72
    s_mov_b32 s65, s73
    s_cmp_eq_u32 s4, 1
    s_cselect_b32 s28, s44, s42
    s_cselect_b32 s29, s45, s43
    s_cmp_eq_u32 s4, 2
    s_cselect_b32 s28, s54, s28
    s_cselect_b32 s29, s55, s29
    s_movk_i32 s30, 1024
    s_mov_b32 s31, 0x00020000
    s_mov_b32 s68, 14385152
    buffer_load_dword v203, off, s[12:15], s68
    buffer_load_dwordx4 v[204:207], v202, s[8:11], 0 offen
    buffer_load_dwordx4 v[208:211], v202, s[8:11], 0 offen offset:16
    buffer_load_dwordx4 v[212:215], v201, s[24:27], 0 offen
    buffer_load_dwordx4 v[216:219], v201, s[24:27], 0 offen offset:16
    s_lshl_b32 s68, s35, 6
    buffer_load_ushort v231, off, s[28:31], s68
    v_lshrrev_b32 v18, 1, v2
    v_and_b32 v18, 7, v18
    v_lshl_add_u32 v19, v2, 7, s6
    v_add_u32 v20, 0, v1
    v_xor_b32 v20, v20, v18
    v_lshl_add_u32 v8, v20, 4, v19
    v_add_u32 v20, 2, v1
    v_xor_b32 v20, v20, v18
    v_lshl_add_u32 v9, v20, 4, v19
    v_add_u32 v20, 4, v1
    v_xor_b32 v20, v20, v18
    v_lshl_add_u32 v10, v20, 4, v19
    v_add_u32 v20, 6, v1
    v_xor_b32 v20, v20, v18
    v_lshl_add_u32 v11, v20, 4, v19
    v_bfe_u32 v18, v0, 2, 2
    v_lshl_add_u32 v18, v1, 3, v18
    v_mul_u32_u24 v18, 192, v18
    v_bfe_u32 v19, v0, 4, 1
    v_lshl_add_u32 v18, v19, 5, v18
    v_and_b32 v19, 3, v0
    v_lshl_add_u32 v18, v19, 3, v18
    v_add_u32 v12, 49152, v18
    v_and_b32 v13, 0x33, v0
    v_bfe_u32 v19, v0, 2, 1
    v_lshl_or_b32 v13, v19, 3, v13
    v_bfe_u32 v19, v0, 3, 1
    v_lshl_or_b32 v13, v19, 2, v13
    v_lshlrev_b32 v13, 4, v13
    v_add_u32 v13, 2097152, v13
    v_bfe_u32 v14, v0, 4, 1
    v_lshlrev_b32 v14, 16, v14
    v_lshl_add_u32 v14, v1, 8, v14
    v_and_b32 v20, 15, v0
    v_lshl_add_u32 v14, v20, 4, v14
    v_add_u32 v14, 4194304, v14
    s_lshl_b32 s42, s7, 10
    s_lshl_b32 s43, s35, 17
    s_add_u32 s42, s42, s43
    s_lshr_b32 s43, s35, 1
    s_lshl_b32 s43, s43, 18
    s_lshl_b32 s68, s7, 10
    s_add_u32 s43, s43, s68
    s_lshl_b32 s41, s35, 6
    s_add_u32 s41, s41, s7
    s_lshl_b32 s69, s37, 3
    s_lshl_b32 s68, s4, 1
    s_add_u32 s69, s69, s68
    s_add_u32 s46, s69, s5
    s_lshl_b32 s76, s36, 16
    s_lshl_b32 s77, s69, 10
    s_add_u32 s77, s77, s76
    s_mul_i32 s72, s5, 86016
    s_mov_b32 s44, 0xffff
    s_mov_b32 s45, 0xffff
    s_lshl_b32 s49, s38, 1
    s_add_u32 s49, s49, s5
    s_lshl_b32 s73, s5, 15
    s_add_u32 s73, s73, s76
    s_add_u32 s73, s73, 2097152
    s_lshl_b32 s62, s37, 2
    s_lshl_b32 s69, s4, 1
    s_add_u32 s62, s62, s69
    s_lshl_b32 s63, s4, 12
    s_add_u32 s63, s63, s72
    s_and_b32 s74, s62, 31
    s_lshl_b32 s74, s74, 10
    s_add_u32 s74, s74, s73
    v_lshrrev_b32 v4, 5, v0
    v_and_b32 v5, 15, v0
    v_lshlrev_b32 v5, 4, v5
    v_lshl_add_u32 v5, v4, 8, v5
    v_add_u32 v2, s72, v5
    v_add_u32 v250, s72, v3
    s_lshl_b32 s68, s4, 4
    s_lshl_b32 s69, s5, 2
    s_add_u32 s68, s68, s69
    s_add_u32 s68, s68, 161920
    v_mov_b32 v1, s68
    v_and_b32 v4, 27, v0
    v_mov_b32 v5, 0x3f803f80
    v_cmp_eq_u32 vcc, 16, v4
    v_mov_b32 v7, 0xdddddddd
    v_mov_b64 v[32:33], 0
    v_mov_b64 v[34:35], 0
    v_mov_b64 v[36:37], 0
    v_mov_b64 v[38:39], 0
    v_mov_b64 v[40:41], 0
    v_mov_b64 v[42:43], 0
    v_mov_b64 v[44:45], 0
    v_mov_b64 v[46:47], 0
    v_mov_b64 v[48:49], 0
    v_mov_b64 v[50:51], 0
    v_mov_b64 v[52:53], 0
    v_mov_b64 v[54:55], 0
    v_mov_b64 v[56:57], 0
    v_mov_b64 v[58:59], 0
    v_mov_b64 v[60:61], 0
    v_mov_b64 v[62:63], 0
    v_mov_b64 v[64:65], 0
    v_mov_b64 v[66:67], 0
    v_mov_b64 v[68:69], 0
    v_mov_b64 v[70:71], 0
    v_cndmask_b32 v4, 0, v5, vcc
    v_mov_b32 v5, v4
    v_mov_b64 v[88:89], v[4:5]
    v_mov_b64 v[90:91], v[4:5]
    v_mov_b64 v[92:93], v[4:5]
    v_mov_b64 v[94:95], v[4:5]
    v_mov_b64 v[96:97], v[4:5]
    v_mov_b64 v[98:99], v[4:5]
    v_mov_b64 v[100:101], v[4:5]
    v_mov_b64 v[102:103], v[4:5]
    s_waitcnt lgkmcnt(0)
    s_barrier
    ds_read_b128 v[152:155], v8 offset:0
    ds_read_b64_tr_b16 v[156:157], v12 offset:0
    ds_read_b64_tr_b16 v[158:159], v12 offset:768
    ds_read_b64_tr_b16 v[160:161], v12 offset:64
    ds_read_b64_tr_b16 v[162:163], v12 offset:832
    ds_read_b64_tr_b16 v[164:165], v12 offset:128
    ds_read_b64_tr_b16 v[166:167], v12 offset:896
    ds_read_b128 v[168:171], v9 offset:0
    ds_read_b64_tr_b16 v[172:173], v12 offset:3072
    ds_read_b64_tr_b16 v[174:175], v12 offset:3840
    ds_read_b64_tr_b16 v[176:177], v12 offset:3136
    ds_read_b64_tr_b16 v[178:179], v12 offset:3904
    ds_read_b64_tr_b16 v[180:181], v12 offset:3200
    ds_read_b64_tr_b16 v[182:183], v12 offset:3968
    s_waitcnt lgkmcnt(7)
    v_mfma_f32_32x32x16_bf16 v[104:119], v[156:159], v[152:155], 0
    v_mfma_f32_32x32x16_bf16 v[120:135], v[160:163], v[152:155], 0
    v_mfma_f32_32x32x16_bf16 v[136:151], v[152:155], v[164:167], 0
    ds_read_b128 v[184:187], v10 offset:0
    ds_read_b64_tr_b16 v[188:189], v12 offset:6144
    ds_read_b64_tr_b16 v[190:191], v12 offset:6912
    ds_read_b64_tr_b16 v[192:193], v12 offset:6208
    ds_read_b64_tr_b16 v[194:195], v12 offset:6976
    ds_read_b64_tr_b16 v[196:197], v12 offset:6272
    ds_read_b64_tr_b16 v[198:199], v12 offset:7040
    s_waitcnt lgkmcnt(7)
    v_mfma_f32_32x32x16_bf16 v[104:119], v[172:175], v[168:171], v[104:119]
    v_mfma_f32_32x32x16_bf16 v[120:135], v[176:179], v[168:171], v[120:135]
    v_mfma_f32_32x32x16_bf16 v[136:151], v[168:171], v[180:183], v[136:151]
    ds_read_b128 v[152:155], v11 offset:0
    ds_read_b64_tr_b16 v[156:157], v12 offset:9216
    ds_read_b64_tr_b16 v[158:159], v12 offset:9984
    ds_read_b64_tr_b16 v[160:161], v12 offset:9280
    ds_read_b64_tr_b16 v[162:163], v12 offset:10048
    ds_read_b64_tr_b16 v[164:165], v12 offset:9344
    ds_read_b64_tr_b16 v[166:167], v12 offset:10112
    s_waitcnt lgkmcnt(7)
    v_mfma_f32_32x32x16_bf16 v[104:119], v[188:191], v[184:187], v[104:119]
    v_mfma_f32_32x32x16_bf16 v[120:135], v[192:195], v[184:187], v[120:135]
    v_mfma_f32_32x32x16_bf16 v[136:151], v[184:187], v[196:199], v[136:151]
    s_waitcnt lgkmcnt(0)
    s_barrier
    ds_read_b128 v[168:171], v8 offset:4096
    ds_read_b64_tr_b16 v[172:173], v12 offset:12288
    ds_read_b64_tr_b16 v[174:175], v12 offset:13056
    ds_read_b64_tr_b16 v[176:177], v12 offset:12352
    ds_read_b64_tr_b16 v[178:179], v12 offset:13120
    ds_read_b64_tr_b16 v[180:181], v12 offset:12416
    ds_read_b64_tr_b16 v[182:183], v12 offset:13184
    v_mfma_f32_32x32x16_bf16 v[104:119], v[156:159], v[152:155], v[104:119]
    v_mfma_f32_32x32x16_bf16 v[120:135], v[160:163], v[152:155], v[120:135]
    v_mfma_f32_32x32x16_bf16 v[136:151], v[152:155], v[164:167], v[136:151]
    ds_read_b128 v[184:187], v9 offset:4096
    ds_read_b64_tr_b16 v[188:189], v12 offset:15360
    ds_read_b64_tr_b16 v[190:191], v12 offset:16128
    ds_read_b64_tr_b16 v[192:193], v12 offset:15424
    ds_read_b64_tr_b16 v[194:195], v12 offset:16192
    ds_read_b64_tr_b16 v[196:197], v12 offset:15488
    ds_read_b64_tr_b16 v[198:199], v12 offset:16256
    s_waitcnt lgkmcnt(7)
    v_mfma_f32_32x32x16_bf16 v[104:119], v[172:175], v[168:171], v[104:119]
    v_mfma_f32_32x32x16_bf16 v[120:135], v[176:179], v[168:171], v[120:135]
    v_mfma_f32_32x32x16_bf16 v[136:151], v[168:171], v[180:183], v[136:151]
    ds_read_b128 v[152:155], v10 offset:4096
    ds_read_b64_tr_b16 v[156:157], v12 offset:18432
    ds_read_b64_tr_b16 v[158:159], v12 offset:19200
    ds_read_b64_tr_b16 v[160:161], v12 offset:18496
    ds_read_b64_tr_b16 v[162:163], v12 offset:19264
    ds_read_b64_tr_b16 v[164:165], v12 offset:18560
    ds_read_b64_tr_b16 v[166:167], v12 offset:19328
    s_waitcnt lgkmcnt(7)
    v_mfma_f32_32x32x16_bf16 v[104:119], v[188:191], v[184:187], v[104:119]
    v_mfma_f32_32x32x16_bf16 v[120:135], v[192:195], v[184:187], v[120:135]
    v_mfma_f32_32x32x16_bf16 v[136:151], v[184:187], v[196:199], v[136:151]
    ds_read_b128 v[168:171], v11 offset:4096
    ds_read_b64_tr_b16 v[172:173], v12 offset:21504
    ds_read_b64_tr_b16 v[174:175], v12 offset:22272
    ds_read_b64_tr_b16 v[176:177], v12 offset:21568
    ds_read_b64_tr_b16 v[178:179], v12 offset:22336
    ds_read_b64_tr_b16 v[180:181], v12 offset:21632
    ds_read_b64_tr_b16 v[182:183], v12 offset:22400
    s_waitcnt lgkmcnt(7)
    v_mfma_f32_32x32x16_bf16 v[104:119], v[156:159], v[152:155], v[104:119]
    v_mfma_f32_32x32x16_bf16 v[120:135], v[160:163], v[152:155], v[120:135]
    v_mfma_f32_32x32x16_bf16 v[136:151], v[152:155], v[164:167], v[136:151]
    s_waitcnt lgkmcnt(0)
    s_barrier
    ds_read_b128 v[184:187], v8 offset:8192
    ds_read_b64_tr_b16 v[188:189], v12 offset:24576
    ds_read_b64_tr_b16 v[190:191], v12 offset:25344
    ds_read_b64_tr_b16 v[192:193], v12 offset:24640
    ds_read_b64_tr_b16 v[194:195], v12 offset:25408
    ds_read_b64_tr_b16 v[196:197], v12 offset:24704
    ds_read_b64_tr_b16 v[198:199], v12 offset:25472
    v_mfma_f32_32x32x16_bf16 v[104:119], v[172:175], v[168:171], v[104:119]
    v_mfma_f32_32x32x16_bf16 v[120:135], v[176:179], v[168:171], v[120:135]
    v_mfma_f32_32x32x16_bf16 v[136:151], v[168:171], v[180:183], v[136:151]
    ds_read_b128 v[152:155], v9 offset:8192
    ds_read_b64_tr_b16 v[156:157], v12 offset:27648
    ds_read_b64_tr_b16 v[158:159], v12 offset:28416
    ds_read_b64_tr_b16 v[160:161], v12 offset:27712
    ds_read_b64_tr_b16 v[162:163], v12 offset:28480
    ds_read_b64_tr_b16 v[164:165], v12 offset:27776
    ds_read_b64_tr_b16 v[166:167], v12 offset:28544
    s_waitcnt vmcnt(0)
    v_readfirstlane_b32 s32, v203
    v_mov_b32 v220, 0
    v_dot2_f32_bf16 v220, v204, v212, v220
    v_dot2_f32_bf16 v220, v205, v213, v220
    v_dot2_f32_bf16 v220, v206, v214, v220
    v_dot2_f32_bf16 v220, v207, v215, v220
    v_dot2_f32_bf16 v220, v208, v216, v220
    v_dot2_f32_bf16 v220, v209, v217, v220
    v_dot2_f32_bf16 v220, v210, v218, v220
    v_dot2_f32_bf16 v220, v211, v219, v220
    s_mul_i32 s32, s32, 0x9E3779B1
    s_add_u32 s32, s32, 0x7F4A7C15
    s_xor_b32 s33, s32, 0x5BD1E995
    v_mov_b32 v224, -1
    v_mov_b32 v225, -1
    v_mov_b32 v226, -1
    v_mov_b32 v227, -1
    s_lshl_b32 s68, s46, 15
    s_lshl_b32 s69, s36, 10
    s_add_u32 s68, s68, s69
    s_add_u32 s68, s68, 16785408
    s_add_u32 s69, s68, 0x8000
    buffer_store_dwordx4 v[224:227], v3, s[12:15], s68 offen sc1
    buffer_store_dwordx4 v[224:227], v3, s[12:15], s69 offen sc1
    v_add_f32_dpp v220, v220, v220 row_ror:8 row_mask:0xf bank_mask:0xf
    s_nop 1
    v_add_f32_dpp v220, v220, v220 row_ror:4 row_mask:0xf bank_mask:0xf
    s_nop 1
    v_add_f32_dpp v220, v220, v220 row_ror:2 row_mask:0xf bank_mask:0xf
    s_nop 1
    v_add_f32_dpp v220, v220, v220 row_ror:1 row_mask:0xf bank_mask:0xf
    v_mov_b32 v221, v220
    s_nop 1
    v_permlane16_swap_b32 v221, v220
    v_add_f32 v220, v220, v221
    v_cvt_pk_bf16_f32 v220, v220, v220
    v_and_b32 v220, 0xffff0000, v220
    v_mul_f32 v220, 0xbfb8aa3b, v220
    v_exp_f32 v220, v220
    s_nop 0
    v_add_f32 v220, 1.0, v220
    v_rcp_f32 v220, v220
    s_nop 0
    v_cvt_pk_bf16_f32 v220, v220, v220
    v_and_b32 v220, 0xffff0000, v220
    v_lshrrev_b32 v221, 3, v200
    v_and_b32 v200, 7, v200
    v_lshlrev_b32 v200, 2, v200
    v_lshl_add_u32 v200, v221, 7, v200
    s_mov_b32 s68, 14155776
    buffer_store_dword v220, v200, s[12:15], s68 offen sc1
    s_waitcnt lgkmcnt(7)
    v_mfma_f32_32x32x16_bf16 v[104:119], v[188:191], v[184:187], v[104:119]
    v_mfma_f32_32x32x16_bf16 v[120:135], v[192:195], v[184:187], v[120:135]
    v_mfma_f32_32x32x16_bf16 v[136:151], v[184:187], v[196:199], v[136:151]
    ds_read_b128 v[168:171], v10 offset:8192
    ds_read_b64_tr_b16 v[172:173], v12 offset:30720
    ds_read_b64_tr_b16 v[174:175], v12 offset:31488
    ds_read_b64_tr_b16 v[176:177], v12 offset:30784
    ds_read_b64_tr_b16 v[178:179], v12 offset:31552
    ds_read_b64_tr_b16 v[180:181], v12 offset:30848
    ds_read_b64_tr_b16 v[182:183], v12 offset:31616
    s_waitcnt lgkmcnt(7)
    v_mfma_f32_32x32x16_bf16 v[104:119], v[156:159], v[152:155], v[104:119]
    v_mfma_f32_32x32x16_bf16 v[120:135], v[160:163], v[152:155], v[120:135]
    v_mfma_f32_32x32x16_bf16 v[136:151], v[152:155], v[164:167], v[136:151]
    ds_read_b128 v[184:187], v11 offset:8192
    ds_read_b64_tr_b16 v[188:189], v12 offset:33792
    ds_read_b64_tr_b16 v[190:191], v12 offset:34560
    ds_read_b64_tr_b16 v[192:193], v12 offset:33856
    ds_read_b64_tr_b16 v[194:195], v12 offset:34624
    ds_read_b64_tr_b16 v[196:197], v12 offset:33920
    ds_read_b64_tr_b16 v[198:199], v12 offset:34688
    s_waitcnt lgkmcnt(7)
    v_mfma_f32_32x32x16_bf16 v[104:119], v[172:175], v[168:171], v[104:119]
    v_mfma_f32_32x32x16_bf16 v[120:135], v[176:179], v[168:171], v[120:135]
    v_mfma_f32_32x32x16_bf16 v[136:151], v[168:171], v[180:183], v[136:151]
    s_waitcnt lgkmcnt(0)
    s_barrier
    ds_read_b128 v[152:155], v8 offset:0
    ds_read_b64_tr_b16 v[156:157], v12 offset:0
    ds_read_b64_tr_b16 v[158:159], v12 offset:768
    ds_read_b64_tr_b16 v[160:161], v12 offset:64
    ds_read_b64_tr_b16 v[162:163], v12 offset:832
    ds_read_b64_tr_b16 v[164:165], v12 offset:128
    ds_read_b64_tr_b16 v[166:167], v12 offset:896
    v_mfma_f32_32x32x16_bf16 v[104:119], v[188:191], v[184:187], v[104:119]
    v_mfma_f32_32x32x16_bf16 v[120:135], v[192:195], v[184:187], v[120:135]
    v_mfma_f32_32x32x16_bf16 v[136:151], v[184:187], v[196:199], v[136:151]
    ds_read_b128 v[168:171], v9 offset:0
    ds_read_b64_tr_b16 v[172:173], v12 offset:3072
    ds_read_b64_tr_b16 v[174:175], v12 offset:3840
    ds_read_b64_tr_b16 v[176:177], v12 offset:3136
    ds_read_b64_tr_b16 v[178:179], v12 offset:3904
    ds_read_b64_tr_b16 v[180:181], v12 offset:3200
    ds_read_b64_tr_b16 v[182:183], v12 offset:3968
    s_waitcnt lgkmcnt(7)
    v_mfma_f32_32x32x16_bf16 v[104:119], v[156:159], v[152:155], v[104:119]
    v_mfma_f32_32x32x16_bf16 v[120:135], v[160:163], v[152:155], v[120:135]
    v_mfma_f32_32x32x16_bf16 v[136:151], v[152:155], v[164:167], v[136:151]
    ds_read_b128 v[184:187], v10 offset:0
    ds_read_b64_tr_b16 v[188:189], v12 offset:6144
    ds_read_b64_tr_b16 v[190:191], v12 offset:6912
    ds_read_b64_tr_b16 v[192:193], v12 offset:6208
    ds_read_b64_tr_b16 v[194:195], v12 offset:6976
    ds_read_b64_tr_b16 v[196:197], v12 offset:6272
    ds_read_b64_tr_b16 v[198:199], v12 offset:7040
    s_waitcnt lgkmcnt(7)
    v_mfma_f32_32x32x16_bf16 v[104:119], v[172:175], v[168:171], v[104:119]
    v_mfma_f32_32x32x16_bf16 v[120:135], v[176:179], v[168:171], v[120:135]
    v_mfma_f32_32x32x16_bf16 v[136:151], v[168:171], v[180:183], v[136:151]
    ds_read_b128 v[152:155], v11 offset:0
    ds_read_b64_tr_b16 v[156:157], v12 offset:9216
    ds_read_b64_tr_b16 v[158:159], v12 offset:9984
    ds_read_b64_tr_b16 v[160:161], v12 offset:9280
    ds_read_b64_tr_b16 v[162:163], v12 offset:10048
    ds_read_b64_tr_b16 v[164:165], v12 offset:9344
    ds_read_b64_tr_b16 v[166:167], v12 offset:10112
    s_waitcnt lgkmcnt(7)
    v_mfma_f32_32x32x16_bf16 v[104:119], v[188:191], v[184:187], v[104:119]
    v_mfma_f32_32x32x16_bf16 v[120:135], v[192:195], v[184:187], v[120:135]
    v_mfma_f32_32x32x16_bf16 v[136:151], v[184:187], v[196:199], v[136:151]
    s_waitcnt lgkmcnt(0)
    s_barrier
    ds_read_b128 v[168:171], v8 offset:4096
    ds_read_b64_tr_b16 v[172:173], v12 offset:12288
    ds_read_b64_tr_b16 v[174:175], v12 offset:13056
    ds_read_b64_tr_b16 v[176:177], v12 offset:12352
    ds_read_b64_tr_b16 v[178:179], v12 offset:13120
    ds_read_b64_tr_b16 v[180:181], v12 offset:12416
    ds_read_b64_tr_b16 v[182:183], v12 offset:13184
    v_mfma_f32_32x32x16_bf16 v[104:119], v[156:159], v[152:155], v[104:119]
    v_mfma_f32_32x32x16_bf16 v[120:135], v[160:163], v[152:155], v[120:135]
    v_mfma_f32_32x32x16_bf16 v[136:151], v[152:155], v[164:167], v[136:151]
    ds_read_b128 v[184:187], v9 offset:4096
    ds_read_b64_tr_b16 v[188:189], v12 offset:15360
    ds_read_b64_tr_b16 v[190:191], v12 offset:16128
    ds_read_b64_tr_b16 v[192:193], v12 offset:15424
    ds_read_b64_tr_b16 v[194:195], v12 offset:16192
    ds_read_b64_tr_b16 v[196:197], v12 offset:15488
    ds_read_b64_tr_b16 v[198:199], v12 offset:16256
    s_waitcnt lgkmcnt(7)
    v_mfma_f32_32x32x16_bf16 v[104:119], v[172:175], v[168:171], v[104:119]
    v_mfma_f32_32x32x16_bf16 v[120:135], v[176:179], v[168:171], v[120:135]
    v_mfma_f32_32x32x16_bf16 v[136:151], v[168:171], v[180:183], v[136:151]
    ds_read_b128 v[152:155], v10 offset:4096
    ds_read_b64_tr_b16 v[156:157], v12 offset:18432
    ds_read_b64_tr_b16 v[158:159], v12 offset:19200
    ds_read_b64_tr_b16 v[160:161], v12 offset:18496
    ds_read_b64_tr_b16 v[162:163], v12 offset:19264
    ds_read_b64_tr_b16 v[164:165], v12 offset:18560
    ds_read_b64_tr_b16 v[166:167], v12 offset:19328
    s_waitcnt lgkmcnt(7)
    v_mfma_f32_32x32x16_bf16 v[104:119], v[188:191], v[184:187], v[104:119]
    v_mfma_f32_32x32x16_bf16 v[120:135], v[192:195], v[184:187], v[120:135]
    v_mfma_f32_32x32x16_bf16 v[136:151], v[184:187], v[196:199], v[136:151]
    ds_read_b128 v[168:171], v11 offset:4096
    ds_read_b64_tr_b16 v[172:173], v12 offset:21504
    ds_read_b64_tr_b16 v[174:175], v12 offset:22272
    ds_read_b64_tr_b16 v[176:177], v12 offset:21568
    ds_read_b64_tr_b16 v[178:179], v12 offset:22336
    ds_read_b64_tr_b16 v[180:181], v12 offset:21632
    ds_read_b64_tr_b16 v[182:183], v12 offset:22400
    s_waitcnt lgkmcnt(7)
    v_mfma_f32_32x32x16_bf16 v[104:119], v[156:159], v[152:155], v[104:119]
    v_mfma_f32_32x32x16_bf16 v[120:135], v[160:163], v[152:155], v[120:135]
    v_mfma_f32_32x32x16_bf16 v[136:151], v[152:155], v[164:167], v[136:151]
    s_waitcnt lgkmcnt(0)
    s_barrier
    ds_read_b128 v[184:187], v8 offset:8192
    ds_read_b64_tr_b16 v[188:189], v12 offset:24576
    ds_read_b64_tr_b16 v[190:191], v12 offset:25344
    ds_read_b64_tr_b16 v[192:193], v12 offset:24640
    ds_read_b64_tr_b16 v[194:195], v12 offset:25408
    ds_read_b64_tr_b16 v[196:197], v12 offset:24704
    ds_read_b64_tr_b16 v[198:199], v12 offset:25472
    v_mfma_f32_32x32x16_bf16 v[104:119], v[172:175], v[168:171], v[104:119]
    v_mfma_f32_32x32x16_bf16 v[120:135], v[176:179], v[168:171], v[120:135]
    v_mfma_f32_32x32x16_bf16 v[136:151], v[168:171], v[180:183], v[136:151]
    ds_read_b128 v[152:155], v9 offset:8192
    ds_read_b64_tr_b16 v[156:157], v12 offset:27648
    ds_read_b64_tr_b16 v[158:159], v12 offset:28416
    ds_read_b64_tr_b16 v[160:161], v12 offset:27712
    ds_read_b64_tr_b16 v[162:163], v12 offset:28480
    ds_read_b64_tr_b16 v[164:165], v12 offset:27776
    ds_read_b64_tr_b16 v[166:167], v12 offset:28544
    s_waitcnt lgkmcnt(7)
    v_mfma_f32_32x32x16_bf16 v[104:119], v[188:191], v[184:187], v[104:119]
    v_mfma_f32_32x32x16_bf16 v[120:135], v[192:195], v[184:187], v[120:135]
    v_mfma_f32_32x32x16_bf16 v[136:151], v[184:187], v[196:199], v[136:151]
    ds_read_b128 v[168:171], v10 offset:8192
    ds_read_b64_tr_b16 v[172:173], v12 offset:30720
    ds_read_b64_tr_b16 v[174:175], v12 offset:31488
    ds_read_b64_tr_b16 v[176:177], v12 offset:30784
    ds_read_b64_tr_b16 v[178:179], v12 offset:31552
    ds_read_b64_tr_b16 v[180:181], v12 offset:30848
    ds_read_b64_tr_b16 v[182:183], v12 offset:31616
    s_waitcnt lgkmcnt(7)
    v_mfma_f32_32x32x16_bf16 v[104:119], v[156:159], v[152:155], v[104:119]
    v_mfma_f32_32x32x16_bf16 v[120:135], v[160:163], v[152:155], v[120:135]
    v_mfma_f32_32x32x16_bf16 v[136:151], v[152:155], v[164:167], v[136:151]
    ds_read_b128 v[184:187], v11 offset:8192
    ds_read_b64_tr_b16 v[188:189], v12 offset:33792
    ds_read_b64_tr_b16 v[190:191], v12 offset:34560
    ds_read_b64_tr_b16 v[192:193], v12 offset:33856
    ds_read_b64_tr_b16 v[194:195], v12 offset:34624
    ds_read_b64_tr_b16 v[196:197], v12 offset:33920
    ds_read_b64_tr_b16 v[198:199], v12 offset:34688
    s_waitcnt lgkmcnt(7)
    v_mfma_f32_32x32x16_bf16 v[104:119], v[172:175], v[168:171], v[104:119]
    v_mfma_f32_32x32x16_bf16 v[120:135], v[176:179], v[168:171], v[120:135]
    v_mfma_f32_32x32x16_bf16 v[136:151], v[168:171], v[180:183], v[136:151]
    s_waitcnt lgkmcnt(0)
    s_barrier
    ds_read_b128 v[152:155], v8 offset:0
    ds_read_b64_tr_b16 v[156:157], v12 offset:0
    ds_read_b64_tr_b16 v[158:159], v12 offset:768
    ds_read_b64_tr_b16 v[160:161], v12 offset:64
    ds_read_b64_tr_b16 v[162:163], v12 offset:832
    ds_read_b64_tr_b16 v[164:165], v12 offset:128
    ds_read_b64_tr_b16 v[166:167], v12 offset:896
    v_mfma_f32_32x32x16_bf16 v[104:119], v[188:191], v[184:187], v[104:119]
    v_mfma_f32_32x32x16_bf16 v[120:135], v[192:195], v[184:187], v[120:135]
    v_mfma_f32_32x32x16_bf16 v[136:151], v[184:187], v[196:199], v[136:151]
    ds_read_b128 v[168:171], v9 offset:0
    ds_read_b64_tr_b16 v[172:173], v12 offset:3072
    ds_read_b64_tr_b16 v[174:175], v12 offset:3840
    ds_read_b64_tr_b16 v[176:177], v12 offset:3136
    ds_read_b64_tr_b16 v[178:179], v12 offset:3904
    ds_read_b64_tr_b16 v[180:181], v12 offset:3200
    ds_read_b64_tr_b16 v[182:183], v12 offset:3968
    s_waitcnt lgkmcnt(7)
    v_mfma_f32_32x32x16_bf16 v[104:119], v[156:159], v[152:155], v[104:119]
    v_mfma_f32_32x32x16_bf16 v[120:135], v[160:163], v[152:155], v[120:135]
    v_mfma_f32_32x32x16_bf16 v[136:151], v[152:155], v[164:167], v[136:151]
    ds_read_b128 v[184:187], v10 offset:0
    ds_read_b64_tr_b16 v[188:189], v12 offset:6144
    ds_read_b64_tr_b16 v[190:191], v12 offset:6912
    ds_read_b64_tr_b16 v[192:193], v12 offset:6208
    ds_read_b64_tr_b16 v[194:195], v12 offset:6976
    ds_read_b64_tr_b16 v[196:197], v12 offset:6272
    ds_read_b64_tr_b16 v[198:199], v12 offset:7040
    s_waitcnt lgkmcnt(7)
    v_mfma_f32_32x32x16_bf16 v[104:119], v[172:175], v[168:171], v[104:119]
    v_mfma_f32_32x32x16_bf16 v[120:135], v[176:179], v[168:171], v[120:135]
    v_mfma_f32_32x32x16_bf16 v[136:151], v[168:171], v[180:183], v[136:151]
    ds_read_b128 v[152:155], v11 offset:0
    ds_read_b64_tr_b16 v[156:157], v12 offset:9216
    ds_read_b64_tr_b16 v[158:159], v12 offset:9984
    ds_read_b64_tr_b16 v[160:161], v12 offset:9280
    ds_read_b64_tr_b16 v[162:163], v12 offset:10048
    ds_read_b64_tr_b16 v[164:165], v12 offset:9344
    ds_read_b64_tr_b16 v[166:167], v12 offset:10112
    s_waitcnt lgkmcnt(7)
    v_mfma_f32_32x32x16_bf16 v[104:119], v[188:191], v[184:187], v[104:119]
    v_mfma_f32_32x32x16_bf16 v[120:135], v[192:195], v[184:187], v[120:135]
    v_mfma_f32_32x32x16_bf16 v[136:151], v[184:187], v[196:199], v[136:151]
    s_waitcnt vmcnt(0) lgkmcnt(0)
    s_barrier
    ds_read_b128 v[168:171], v8 offset:4096
    ds_read_b64_tr_b16 v[172:173], v12 offset:12288
    ds_read_b64_tr_b16 v[174:175], v12 offset:13056
    ds_read_b64_tr_b16 v[176:177], v12 offset:12352
    ds_read_b64_tr_b16 v[178:179], v12 offset:13120
    ds_read_b64_tr_b16 v[180:181], v12 offset:12416
    ds_read_b64_tr_b16 v[182:183], v12 offset:13184
    v_mfma_f32_32x32x16_bf16 v[104:119], v[156:159], v[152:155], v[104:119]
    v_mfma_f32_32x32x16_bf16 v[120:135], v[160:163], v[152:155], v[120:135]
    v_mfma_f32_32x32x16_bf16 v[136:151], v[152:155], v[164:167], v[136:151]
    ds_read_b128 v[184:187], v9 offset:4096
    ds_read_b64_tr_b16 v[188:189], v12 offset:15360
    ds_read_b64_tr_b16 v[190:191], v12 offset:16128
    ds_read_b64_tr_b16 v[192:193], v12 offset:15424
    ds_read_b64_tr_b16 v[194:195], v12 offset:16192
    ds_read_b64_tr_b16 v[196:197], v12 offset:15488
    ds_read_b64_tr_b16 v[198:199], v12 offset:16256
    s_waitcnt lgkmcnt(7)
    v_mfma_f32_32x32x16_bf16 v[104:119], v[172:175], v[168:171], v[104:119]
    v_mfma_f32_32x32x16_bf16 v[120:135], v[176:179], v[168:171], v[120:135]
    v_mfma_f32_32x32x16_bf16 v[136:151], v[168:171], v[180:183], v[136:151]
    ds_read_b128 v[152:155], v10 offset:4096
    ds_read_b64_tr_b16 v[156:157], v12 offset:18432
    ds_read_b64_tr_b16 v[158:159], v12 offset:19200
    ds_read_b64_tr_b16 v[160:161], v12 offset:18496
    ds_read_b64_tr_b16 v[162:163], v12 offset:19264
    ds_read_b64_tr_b16 v[164:165], v12 offset:18560
    ds_read_b64_tr_b16 v[166:167], v12 offset:19328
    s_waitcnt lgkmcnt(7)
    v_mfma_f32_32x32x16_bf16 v[104:119], v[188:191], v[184:187], v[104:119]
    v_mfma_f32_32x32x16_bf16 v[120:135], v[192:195], v[184:187], v[120:135]
    v_mfma_f32_32x32x16_bf16 v[136:151], v[184:187], v[196:199], v[136:151]
    ds_read_b128 v[168:171], v11 offset:4096
    ds_read_b64_tr_b16 v[172:173], v12 offset:21504
    ds_read_b64_tr_b16 v[174:175], v12 offset:22272
    ds_read_b64_tr_b16 v[176:177], v12 offset:21568
    ds_read_b64_tr_b16 v[178:179], v12 offset:22336
    ds_read_b64_tr_b16 v[180:181], v12 offset:21632
    ds_read_b64_tr_b16 v[182:183], v12 offset:22400
    s_waitcnt lgkmcnt(7)
    v_mfma_f32_32x32x16_bf16 v[104:119], v[156:159], v[152:155], v[104:119]
    v_mfma_f32_32x32x16_bf16 v[120:135], v[160:163], v[152:155], v[120:135]
    v_mfma_f32_32x32x16_bf16 v[136:151], v[152:155], v[164:167], v[136:151]
    s_waitcnt lgkmcnt(0)
    s_barrier
    v_mfma_f32_32x32x16_bf16 v[104:119], v[172:175], v[168:171], v[104:119]
    v_mfma_f32_32x32x16_bf16 v[120:135], v[176:179], v[168:171], v[120:135]
    v_mfma_f32_32x32x16_bf16 v[136:151], v[168:171], v[180:183], v[136:151]
    s_mov_b32 s71, 0x3eb8aa3b
    s_mov_b32 s70, s71
    s_bitcmp1_b32 s35, 0
    s_cbranch_scc1 L_epiK
    s_nop 6
    v_cvt_pk_bf16_f32 v160, v120, v121
    v_cvt_pk_bf16_f32 v161, v122, v123
    v_cvt_pk_bf16_f32 v162, v124, v125
    v_cvt_pk_bf16_f32 v163, v126, v127
    s_add_u32 s68, s43, 131072
    buffer_store_dwordx4 v[160:163], v3, s[12:15], s68 offen sc1
    v_cvt_pk_bf16_f32 v164, v128, v129
    v_cvt_pk_bf16_f32 v165, v130, v131
    v_cvt_pk_bf16_f32 v166, v132, v133
    v_cvt_pk_bf16_f32 v167, v134, v135
    s_add_u32 s68, s43, 196608
    buffer_store_dwordx4 v[164:167], v3, s[12:15], s68 offen sc1
    v_cvt_pk_bf16_f32 v168, v136, v137
    v_cvt_pk_bf16_f32 v169, v138, v139
    v_cvt_pk_bf16_f32 v170, v140, v141
    v_cvt_pk_bf16_f32 v171, v142, v143
    v_cvt_pk_bf16_f32 v172, v144, v145
    v_cvt_pk_bf16_f32 v173, v146, v147
    v_cvt_pk_bf16_f32 v174, v148, v149
    v_cvt_pk_bf16_f32 v175, v150, v151
    buffer_store_dwordx4 v[168:171], v14, s[12:15], s42 offen sc1
    buffer_store_dwordx4 v[172:175], v14, s[12:15], s42 offen offset:512 sc1
    v_pk_mul_f32 v[104:105], v[104:105], s[70:71]
    v_pk_mul_f32 v[106:107], v[106:107], s[70:71]
    v_pk_mul_f32 v[108:109], v[108:109], s[70:71]
    v_pk_mul_f32 v[110:111], v[110:111], s[70:71]
    v_cvt_pk_bf16_f32 v152, v104, v105
    v_cvt_pk_bf16_f32 v153, v106, v107
    v_cvt_pk_bf16_f32 v154, v108, v109
    v_cvt_pk_bf16_f32 v155, v110, v111
    s_add_u32 s68, s43, 0
    buffer_store_dwordx4 v[152:155], v3, s[12:15], s68 offen sc1
    v_pk_mul_f32 v[112:113], v[112:113], s[70:71]
    v_pk_mul_f32 v[114:115], v[114:115], s[70:71]
    v_pk_mul_f32 v[116:117], v[116:117], s[70:71]
    v_pk_mul_f32 v[118:119], v[118:119], s[70:71]
    v_cvt_pk_bf16_f32 v156, v112, v113
    v_cvt_pk_bf16_f32 v157, v114, v115
    v_cvt_pk_bf16_f32 v158, v116, v117
    v_cvt_pk_bf16_f32 v159, v118, v119
    s_add_u32 s68, s43, 65536
    buffer_store_dwordx4 v[156:159], v3, s[12:15], s68 offen sc1
    s_branch L_epiX
L_epiK:
    s_nop 5
    v_cvt_pk_bf16_f32 v152, v104, v105
    v_cvt_pk_bf16_f32 v153, v106, v107
    v_cvt_pk_bf16_f32 v154, v108, v109
    v_cvt_pk_bf16_f32 v155, v110, v111
    s_add_u32 s68, s43, 0
    buffer_store_dwordx4 v[152:155], v13, s[12:15], s68 offen sc1
    v_cvt_pk_bf16_f32 v156, v112, v113
    v_cvt_pk_bf16_f32 v157, v114, v115
    v_cvt_pk_bf16_f32 v158, v116, v117
    v_cvt_pk_bf16_f32 v159, v118, v119
    s_add_u32 s68, s43, 65536
    buffer_store_dwordx4 v[156:159], v13, s[12:15], s68 offen sc1
    v_cvt_pk_bf16_f32 v168, v136, v137
    v_cvt_pk_bf16_f32 v169, v138, v139
    v_cvt_pk_bf16_f32 v170, v140, v141
    v_cvt_pk_bf16_f32 v171, v142, v143
    v_cvt_pk_bf16_f32 v172, v144, v145
    v_cvt_pk_bf16_f32 v173, v146, v147
    v_cvt_pk_bf16_f32 v174, v148, v149
    v_cvt_pk_bf16_f32 v175, v150, v151
    buffer_store_dwordx4 v[168:171], v14, s[12:15], s42 offen sc1
    buffer_store_dwordx4 v[172:175], v14, s[12:15], s42 offen offset:512 sc1
    v_pk_mul_f32 v[120:121], v[120:121], s[70:71]
    v_pk_mul_f32 v[122:123], v[122:123], s[70:71]
    v_pk_mul_f32 v[124:125], v[124:125], s[70:71]
    v_pk_mul_f32 v[126:127], v[126:127], s[70:71]
    v_cvt_pk_bf16_f32 v160, v120, v121
    v_cvt_pk_bf16_f32 v161, v122, v123
    v_cvt_pk_bf16_f32 v162, v124, v125
    v_cvt_pk_bf16_f32 v163, v126, v127
    s_add_u32 s68, s43, 131072
    buffer_store_dwordx4 v[160:163], v13, s[12:15], s68 offen sc1
    v_pk_mul_f32 v[128:129], v[128:129], s[70:71]
    v_pk_mul_f32 v[130:131], v[130:131], s[70:71]
    v_pk_mul_f32 v[132:133], v[132:133], s[70:71]
    v_pk_mul_f32 v[134:135], v[134:135], s[70:71]
    v_cvt_pk_bf16_f32 v164, v128, v129
    v_cvt_pk_bf16_f32 v165, v130, v131
    v_cvt_pk_bf16_f32 v166, v132, v133
    v_cvt_pk_bf16_f32 v167, v134, v135
    s_add_u32 s68, s43, 196608
    buffer_store_dwordx4 v[164:167], v13, s[12:15], s68 offen sc1
L_epiX:
    s_lshl_b32 s40, s41, 6
    s_add_u32 s40, s40, 14286848
    s_waitcnt vmcnt(0) lgkmcnt(0)
    v_mov_b32 v4, s32
    v_mov_b32 v5, s33
    s_mov_b64 exec, 1
    buffer_store_dwordx2 v[4:5], off, s[12:15], s40 sc1
    s_mov_b64 exec, -1
    s_mov_b32 s68, 161844
    s_cmp_eq_u32 s3, 0
    s_cbranch_scc0 Lgp1
    s_lshr_b32 s48, s36, 2
    s_lshl_b32 s48, s48, 13
    s_add_u32 s48, s48, 14286848
    v_lshlrev_b32 v6, 6, v0
    s_mov_b32 s81, 400000
    s_sleep 24
Lpoll2:
    buffer_load_dwordx2 v[4:5], v6, s[12:15], s48 offen sc1
    s_add_u32 s80, s48, 4096
    buffer_load_dwordx2 v[180:181], v6, s[12:15], s80 offen sc1
    s_sub_u32 s81, s81, 1
    s_cbranch_scc1 Lpollx2
    s_waitcnt vmcnt(0)
    v_cmp_eq_u32 s[78:79], s32, v4
    v_cmp_eq_u32 vcc, s33, v5
    s_nop 0
    s_and_b64 s[78:79], s[78:79], vcc
    v_cmp_eq_u32 vcc, s32, v180
    s_nop 0
    s_and_b64 s[78:79], s[78:79], vcc
    v_cmp_eq_u32 vcc, s33, v181
    s_nop 0
    s_and_b64 s[78:79], s[78:79], vcc
    s_cmp_eq_u64 s[78:79], -1
    s_cbranch_scc1 Lpollx2
    s_sleep 2
    s_branch Lpoll2
Lpollx2:
    s_waitcnt vmcnt(0)
    v_mov_b32 v6, s68
    s_mov_b64 exec, 1
    ds_inc_u32 v6, v7
    s_mov_b64 exec, -1
    s_branch Lgpx1
Lgp1:
    v_mov_b32 v5, s68
    s_mov_b32 s81, 3200000
Lspin3:
    ds_read_b32 v6, v5
    s_sub_u32 s81, s81, 1
    s_cbranch_scc1 Lspinx3
    s_waitcnt lgkmcnt(0)
    v_cmp_ne_u32 s[78:79], 1, v6
    s_nop 0
    s_cmp_eq_u64 s[78:79], 0
    s_cbranch_scc1 Lspinx3
    s_sleep 1
    s_branch Lspin3
Lspinx3:
    s_waitcnt lgkmcnt(0)
Lgpx1:
    buffer_load_dwordx4 v[72:75], v3, s[12:15], s77 offen offset:0 sc1
    buffer_load_dwordx4 v[76:79], v3, s[12:15], s77 offen offset:1024 sc1
    s_mov_b32 m0, s63
    s_add_u32 s70, s74, 2096128
    buffer_load_dwordx4 v3, s[12:15], s74 offen sc1 lds
    buffer_load_dwordx4 v3, s[12:15], s70 offen offset:1024 sc1 lds
    s_sub_u32 s71, s74, 1024
    s_sub_u32 s70, s70, 1024
    buffer_load_dwordx4 v3, s[12:15], s71 offen offset:2048 sc1 lds
    buffer_load_dwordx4 v3, s[12:15], s70 offen offset:3072 sc1 lds
    s_lshl_b32 s68, s5, 3
    s_add_u32 s68, s68, 161808
    s_waitcnt vmcnt(0)
    v_mov_b32 v6, s68
    s_mov_b64 exec, 1
    ds_inc_u32 v6, v7
    s_mov_b64 exec, -1
    v_mov_b32 v5, s68
    s_mov_b32 s81, 3200000
Lspin4:
    ds_read_b32 v6, v5
    s_sub_u32 s81, s81, 1
    s_cbranch_scc1 Lspinx4
    s_waitcnt lgkmcnt(0)
    v_cmp_ne_u32 s[78:79], 4, v6
    s_nop 0
    s_cmp_eq_u64 s[78:79], 0
    s_cbranch_scc1 Lspinx4
    s_sleep 1
    s_branch Lspin4
Lspinx4:
    s_waitcnt lgkmcnt(0)
    ds_read_b128 v[80:83], v250 offset:0
    s_mov_b64 exec, s[44:45]
    ds_read_b128 v[88:91], v2 offset:1024
    ds_read_b128 v[92:95], v2 offset:1536
    s_mov_b64 exec, -1
    ds_read_b128 v[84:87], v250 offset:2048
    s_waitcnt lgkmcnt(0)
    v_mfma_f32_32x32x16_bf16 v[8:23], v[80:83], v[72:75], 0
    s_add_u32 s70, s62, 8
    s_and_b32 s70, s70, 31
    s_lshl_b32 s70, s70, 10
    s_add_u32 s70, s70, s73
    s_add_u32 m0, s63, 16384
    s_add_u32 s71, s70, 2096128
    buffer_load_dwordx4 v3, s[12:15], s70 offen sc1 lds
    buffer_load_dwordx4 v3, s[12:15], s71 offen offset:1024 sc1 lds
    s_add_u32 s70, s62, 9
    s_and_b32 s70, s70, 31
    s_lshl_b32 s70, s70, 10
    s_add_u32 s70, s70, s73
    s_add_u32 m0, s63, 18432
    s_add_u32 s71, s70, 2096128
    buffer_load_dwordx4 v3, s[12:15], s70 offen sc1 lds
    buffer_load_dwordx4 v3, s[12:15], s71 offen offset:1024 sc1 lds
    s_nop 3
    s_branch L_SCHED
L_G1:
    s_lshl_b32 s72, s7, 15
    v_lshrrev_b32 v22, 3, v0
    v_and_b32 v23, 7, v0
    v_bfe_u32 v24, v22, 2, 1
    v_and_b32 v25, 3, v22
    v_lshl_add_u32 v24, v24, 4, v25
    v_add_u32 v18, 0, v22
    v_bfe_u32 v19, v18, 1, 3
    v_xor_b32 v19, v19, v23
    v_lshlrev_b32 v30, 4, v19
    v_lshl_add_u32 v20, v24, 10, v30
    v_add_u32 v20, 0, v20
    v_add_u32 v240, s72, v20
    v_add_u32 v18, 8, v22
    v_bfe_u32 v19, v18, 1, 3
    v_xor_b32 v19, v19, v23
    v_lshlrev_b32 v31, 4, v19
    v_lshl_add_u32 v20, v24, 10, v31
    v_add_u32 v20, 3072, v20
    v_add_u32 v241, s72, v20
    v_add_u32 v18, 16, v22
    v_bfe_u32 v19, v18, 1, 3
    v_xor_b32 v19, v19, v23
    v_lshlrev_b32 v32, 4, v19
    v_lshl_add_u32 v20, v24, 10, v32
    v_add_u32 v20, 6144, v20
    v_add_u32 v242, s72, v20
    v_add_u32 v18, 24, v22
    v_bfe_u32 v19, v18, 1, 3
    v_xor_b32 v19, v19, v23
    v_lshlrev_b32 v33, 4, v19
    v_lshl_add_u32 v20, v24, 10, v33
    v_add_u32 v20, 9216, v20
    v_add_u32 v243, s72, v20
    s_and_b32 s80, s34, 3
    s_lshl_b32 s80, s80, 1
    s_add_u32 s80, s80, s35
    s_mul_i32 s73, s4, 3072
    s_add_u32 s73, s73, 49152
    s_mul_i32 s76, s4, 16*3072
    s_and_b32 s77, s35, 1
    s_lshl_b32 s77, s77, 10
    s_lshr_b32 s78, s35, 1
    s_lshl_b32 s78, s78, 7
    s_add_u32 s78, s78, s77
    s_lshl_b32 s79, s35, 6
    s_add_u32 s79, s79, 1920
    s_movk_i32 s77, 3072
    v_mov_b32 v27, s78
    v_mov_b32 v28, s79
    v_add_u32 v18, 0, v0
    v_mul_u32_u24 v19, 43691, v18
    v_lshrrev_b32 v19, 19, v19
    v_mul_u32_u24 v20, 12, v19
    v_sub_u32 v20, v18, v20
    v_cmp_gt_u32 vcc, 8, v20
    v_lshlrev_b32 v26, 4, v20
    v_mad_u32_u24 v26, v19, s77, v26
    v_cndmask_b32 v21, v28, v27, vcc
    v_add3_u32 v21, v21, v26, s76
    v_subrev_u32 v244, 0, v21
    v_add_u32 v18, 64, v0
    v_mul_u32_u24 v19, 43691, v18
    v_lshrrev_b32 v19, 19, v19
    v_mul_u32_u24 v20, 12, v19
    v_sub_u32 v20, v18, v20
    v_cmp_gt_u32 vcc, 8, v20
    v_lshlrev_b32 v26, 4, v20
    v_mad_u32_u24 v26, v19, s77, v26
    v_cndmask_b32 v21, v28, v27, vcc
    v_add3_u32 v21, v21, v26, s76
    v_subrev_u32 v245, 1024, v21
    v_add_u32 v18, 128, v0
    v_mul_u32_u24 v19, 43691, v18
    v_lshrrev_b32 v19, 19, v19
    v_mul_u32_u24 v20, 12, v19
    v_sub_u32 v20, v18, v20
    v_cmp_gt_u32 vcc, 8, v20
    v_lshlrev_b32 v26, 4, v20
    v_mad_u32_u24 v26, v19, s77, v26
    v_cndmask_b32 v21, v28, v27, vcc
    v_add3_u32 v21, v21, v26, s76
    v_subrev_u32 v246, 2048, v21
    s_waitcnt lgkmcnt(0)
    s_mov_b32 s8, s40
    s_mov_b32 s9, s41
    s_mov_b32 s10, 0x200000
    s_mov_b32 s11, 0x00020000
    s_mov_b32 s16, s60
    s_mov_b32 s17, s61
    s_mov_b32 s18, 0x180000
    s_mov_b32 s19, 0x00020000
    s_add_u32 s74, s80, 0
    s_and_b32 s74, s74, 7
    s_add_u32 m0, s6, 0
    s_lshl_b32 s72, s74, 7
    buffer_load_dwordx4 v240, s[8:11], s72 offen offset:0 lds
    buffer_load_dwordx4 v241, s[8:11], s72 offen offset:1024 lds
    buffer_load_dwordx4 v242, s[8:11], s72 offen offset:2048 lds
    buffer_load_dwordx4 v243, s[8:11], s72 offen offset:3072 lds
    s_add_u32 m0, s73, 0
    s_mul_i32 s72, s74, 196608
    buffer_load_dwordx4 v244, s[16:19], s72 offen offset:0 lds
    buffer_load_dwordx4 v245, s[16:19], s72 offen offset:1024 lds
    buffer_load_dwordx4 v246, s[16:19], s72 offen offset:2048 lds
    s_add_u32 s74, s80, 1
    s_and_b32 s74, s74, 7
    s_add_u32 m0, s6, 4096
    s_lshl_b32 s72, s74, 7
    buffer_load_dwordx4 v240, s[8:11], s72 offen offset:0 lds
    buffer_load_dwordx4 v241, s[8:11], s72 offen offset:1024 lds
    buffer_load_dwordx4 v242, s[8:11], s72 offen offset:2048 lds
    buffer_load_dwordx4 v243, s[8:11], s72 offen offset:3072 lds
    s_add_u32 m0, s73, 12288
    s_mul_i32 s72, s74, 196608
    buffer_load_dwordx4 v244, s[16:19], s72 offen offset:0 lds
    buffer_load_dwordx4 v245, s[16:19], s72 offen offset:1024 lds
    buffer_load_dwordx4 v246, s[16:19], s72 offen offset:2048 lds
    s_mov_b32 s12, s70
    s_mov_b32 s13, s71
    s_mov_b32 s14, 0x1400000
    s_mov_b32 s15, 0x00020000
    s_cmp_lt_u32 s4, 2
    s_cselect_b32 s20, s46, s48
    s_cselect_b32 s21, s47, s49
    s_mov_b32 s22, 524288
    s_mov_b32 s23, 0x00020000
    s_and_b32 s75, s4, 1
    s_lshl_b32 s77, s75, 12
    s_add_u32 s75, s75, s80
    s_lshr_b32 s76, s4, 1
    s_lshl_b32 s76, s76, 15
    s_add_u32 s77, s77, s76
    s_add_u32 s77, s77, 86016
    s_lshl_b32 s69, s35, 15
    v_lshl_add_u32 v20, v22, 10, v30
    v_add_u32 v20, 0, v20
    v_add_u32 v247, s69, v20
    v_lshl_add_u32 v20, v22, 10, v31
    v_add_u32 v20, 7168, v20
    v_add_u32 v248, s69, v20
    v_lshl_add_u32 v20, v22, 10, v32
    v_add_u32 v20, 14336, v20
    v_add_u32 v249, s69, v20
    v_lshl_add_u32 v20, v22, 10, v33
    v_add_u32 v20, 21504, v20
    v_add_u32 v250, s69, v20
    v_lshlrev_b32 v18, 2, v0
    v_add_u32 v18, 161792, v18
    v_mov_b32 v19, 0
    ds_write_b32 v18, v19
    v_bfe_u32 v165, v2, 1, 3
    v_lshlrev_b32 v166, 7, v2
    v_add_u32 v167, s6, v166
    v_add_u32 v166, 86016, v166
    v_add_u32 v160, 0, v1
    v_xor_b32 v160, v160, v165
    v_lshl_add_u32 v224, v160, 4, v167
    v_lshl_add_u32 v228, v160, 4, v166
    v_add_u32 v160, 2, v1
    v_xor_b32 v160, v160, v165
    v_lshl_add_u32 v225, v160, 4, v167
    v_lshl_add_u32 v229, v160, 4, v166
    v_add_u32 v160, 4, v1
    v_xor_b32 v160, v160, v165
    v_lshl_add_u32 v226, v160, 4, v167
    v_lshl_add_u32 v230, v160, 4, v166
    v_add_u32 v160, 6, v1
    v_xor_b32 v160, v160, v165
    v_lshl_add_u32 v227, v160, 4, v167
    v_lshl_add_u32 v231, v160, 4, v166
    s_waitcnt vmcnt(7) lgkmcnt(0)
    s_barrier
    ds_read_b128 v[8:11], v224 offset:0
    ds_read_b128 v[12:15], v225 offset:0
    ds_read_b128 v[16:19], v226 offset:0
    ds_read_b128 v[20:23], v227 offset:0
    s_add_u32 s74, s80, 2
    s_and_b32 s74, s74, 7
    s_add_u32 m0, s6, 8192
    s_lshl_b32 s72, s74, 7
    buffer_load_dwordx4 v240, s[8:11], s72 offen offset:0 lds
    buffer_load_dwordx4 v241, s[8:11], s72 offen offset:1024 lds
    buffer_load_dwordx4 v242, s[8:11], s72 offen offset:2048 lds
    buffer_load_dwordx4 v243, s[8:11], s72 offen offset:3072 lds
    s_add_u32 m0, s73, 24576
    s_mul_i32 s72, s74, 196608
    buffer_load_dwordx4 v244, s[16:19], s72 offen offset:0 lds
    buffer_load_dwordx4 v245, s[16:19], s72 offen offset:1024 lds
    buffer_load_dwordx4 v246, s[16:19], s72 offen offset:2048 lds
    s_waitcnt vmcnt(7) lgkmcnt(0)
    s_barrier
    ds_read_b128 v[24:27], v224 offset:4096
    ds_read_b128 v[28:31], v225 offset:4096
    ds_read_b128 v[32:35], v226 offset:4096
    ds_read_b128 v[36:39], v227 offset:4096
    s_add_u32 s74, s80, 3
    s_and_b32 s74, s74, 7
    s_add_u32 m0, s6, 0
    s_lshl_b32 s72, s74, 7
    buffer_load_dwordx4 v240, s[8:11], s72 offen offset:0 lds
    buffer_load_dwordx4 v241, s[8:11], s72 offen offset:1024 lds
    buffer_load_dwordx4 v242, s[8:11], s72 offen offset:2048 lds
    buffer_load_dwordx4 v243, s[8:11], s72 offen offset:3072 lds
    s_add_u32 m0, s73, 0
    s_mul_i32 s72, s74, 196608
    buffer_load_dwordx4 v244, s[16:19], s72 offen offset:0 lds
    buffer_load_dwordx4 v245, s[16:19], s72 offen offset:1024 lds
    buffer_load_dwordx4 v246, s[16:19], s72 offen offset:2048 lds
    s_waitcnt vmcnt(7) lgkmcnt(0)
    s_barrier
    ds_read_b128 v[40:43], v224 offset:8192
    ds_read_b128 v[44:47], v225 offset:8192
    ds_read_b128 v[48:51], v226 offset:8192
    ds_read_b128 v[52:55], v227 offset:8192
    s_add_u32 s74, s80, 4
    s_and_b32 s74, s74, 7
    s_add_u32 m0, s6, 4096
    s_lshl_b32 s72, s74, 7
    buffer_load_dwordx4 v240, s[8:11], s72 offen offset:0 lds
    buffer_load_dwordx4 v241, s[8:11], s72 offen offset:1024 lds
    buffer_load_dwordx4 v242, s[8:11], s72 offen offset:2048 lds
    buffer_load_dwordx4 v243, s[8:11], s72 offen offset:3072 lds
    s_add_u32 m0, s73, 12288
    s_mul_i32 s72, s74, 196608
    buffer_load_dwordx4 v244, s[16:19], s72 offen offset:0 lds
    buffer_load_dwordx4 v245, s[16:19], s72 offen offset:1024 lds
    buffer_load_dwordx4 v246, s[16:19], s72 offen offset:2048 lds
    s_mov_b32 s68, 14385152
    buffer_load_dword v163, off, s[12:15], s68
    s_lshl_b32 s68, s35, 6
    v_lshl_add_u32 v164, v2, 1, s68
    s_mov_b32 s24, s42
    s_mov_b32 s25, s43
    s_mov_b32 s26, 0x400
    s_mov_b32 s27, 0x00020000
    buffer_load_ushort v210, v164, s[24:27], 0 offen
    s_mov_b32 s28, s44
    s_mov_b32 s29, s45
    s_mov_b32 s30, 0x400
    s_mov_b32 s31, 0x00020000
    buffer_load_ushort v211, v164, s[28:31], 0 offen
    s_mov_b32 s24, s54
    s_mov_b32 s25, s55
    buffer_load_ushort v212, v164, s[24:27], 0 offen
    s_waitcnt vmcnt(11) lgkmcnt(0)
    s_barrier
    ds_read_b128 v[56:59], v224 offset:0
    ds_read_b128 v[60:63], v225 offset:0
    ds_read_b128 v[64:67], v226 offset:0
    ds_read_b128 v[68:71], v227 offset:0
    s_add_u32 s74, s80, 5
    s_and_b32 s74, s74, 7
    s_add_u32 m0, s6, 8192
    s_lshl_b32 s72, s74, 7
    buffer_load_dwordx4 v240, s[8:11], s72 offen offset:0 lds
    buffer_load_dwordx4 v241, s[8:11], s72 offen offset:1024 lds
    buffer_load_dwordx4 v242, s[8:11], s72 offen offset:2048 lds
    buffer_load_dwordx4 v243, s[8:11], s72 offen offset:3072 lds
    s_add_u32 m0, s73, 24576
    s_mul_i32 s72, s74, 196608
    buffer_load_dwordx4 v244, s[16:19], s72 offen offset:0 lds
    buffer_load_dwordx4 v245, s[16:19], s72 offen offset:1024 lds
    buffer_load_dwordx4 v246, s[16:19], s72 offen offset:2048 lds
    s_waitcnt vmcnt(11) lgkmcnt(0)
    s_barrier
    ds_read_b128 v[72:75], v224 offset:4096
    ds_read_b128 v[76:79], v225 offset:4096
    ds_read_b128 v[80:83], v226 offset:4096
    ds_read_b128 v[84:87], v227 offset:4096
    s_add_u32 s74, s80, 6
    s_and_b32 s74, s74, 7
    s_add_u32 m0, s6, 0
    s_lshl_b32 s72, s74, 7
    buffer_load_dwordx4 v240, s[8:11], s72 offen offset:0 lds
    buffer_load_dwordx4 v241, s[8:11], s72 offen offset:1024 lds
    buffer_load_dwordx4 v242, s[8:11], s72 offen offset:2048 lds
    buffer_load_dwordx4 v243, s[8:11], s72 offen offset:3072 lds
    s_add_u32 m0, s73, 0
    s_mul_i32 s72, s74, 196608
    buffer_load_dwordx4 v244, s[16:19], s72 offen offset:0 lds
    buffer_load_dwordx4 v245, s[16:19], s72 offen offset:1024 lds
    buffer_load_dwordx4 v246, s[16:19], s72 offen offset:2048 lds
    s_waitcnt vmcnt(7) lgkmcnt(0)
    s_barrier
    ds_read_b128 v[88:91], v224 offset:8192
    ds_read_b128 v[92:95], v225 offset:8192
    ds_read_b128 v[96:99], v226 offset:8192
    ds_read_b128 v[100:103], v227 offset:8192
    s_add_u32 s74, s80, 7
    s_and_b32 s74, s74, 7
    s_add_u32 m0, s6, 4096
    s_lshl_b32 s72, s74, 7
    buffer_load_dwordx4 v240, s[8:11], s72 offen offset:0 lds
    buffer_load_dwordx4 v241, s[8:11], s72 offen offset:1024 lds
    buffer_load_dwordx4 v242, s[8:11], s72 offen offset:2048 lds
    buffer_load_dwordx4 v243, s[8:11], s72 offen offset:3072 lds
    s_add_u32 m0, s73, 12288
    s_mul_i32 s72, s74, 196608
    buffer_load_dwordx4 v244, s[16:19], s72 offen offset:0 lds
    buffer_load_dwordx4 v245, s[16:19], s72 offen offset:1024 lds
    buffer_load_dwordx4 v246, s[16:19], s72 offen offset:2048 lds
    v_readfirstlane_b32 s32, v163
    v_lshlrev_b32 v210, 16, v210
    v_lshlrev_b32 v211, 16, v211
    v_lshlrev_b32 v212, 16, v212
    v_mul_f32 v212, 0x3fb8aa3b, v212
    v_exp_f32 v212, v212
    s_nop 0
    v_cvt_pk_bf16_f32 v212, v212, v212
    v_and_b32 v212, 0xffff0000, v212
    v_mul_f32 v213, v212, v210
    v_mul_f32 v214, v212, v211
    v_mul_f32 v213, 0x3fb8aa3b, v213
    v_exp_f32 v213, v213
    v_mul_f32 v214, 0x3e22f983, v214
    v_rndne_f32 v215, v214
    v_sub_f32 v214, v214, v215
    v_cos_f32 v215, v214
    v_sin_f32 v216, v214
    v_mul_f32 v200, v213, v215
    v_mul_f32 v201, v213, v216
    v_add_f32 v213, -1.0, v200
    v_mul_f32 v214, v210, v210
    v_fmac_f32 v214, v211, v211
    v_rcp_f32 v214, v214
    v_mul_f32 v215, v213, v210
    v_fmac_f32 v215, v201, v211
    v_mul_f32 v216, v201, v210
    v_fma_f32 v216, -v213, v211, v216
    v_mul_f32 v202, v215, v214
    v_mul_f32 v203, v216, v214
    v_mul_f32 v210, v200, v200
    v_mul_f32 v211, v200, v201
    v_fma_f32 v210, -v201, v201, v210
    v_fmac_f32 v211, v201, v200
    v_mul_f32 v212, v210, v210
    v_mul_f32 v213, v210, v211
    v_fma_f32 v212, -v211, v211, v212
    v_fmac_f32 v213, v211, v210
    v_mul_f32 v210, v212, v212
    v_mul_f32 v211, v212, v213
    v_fma_f32 v210, -v213, v213, v210
    v_fmac_f32 v211, v213, v212
    v_mul_f32 v204, v210, v210
    v_mul_f32 v205, v210, v211
    v_fma_f32 v204, -v211, v211, v204
    v_fmac_f32 v205, v211, v210
    v_mul_f32 v210, v204, v204
    v_mul_f32 v211, v204, v205
    v_fma_f32 v210, -v205, v205, v210
    v_fmac_f32 v211, v205, v204
    v_mul_f32 v212, v210, v210
    v_mul_f32 v213, v210, v211
    v_fma_f32 v212, -v211, v211, v212
    v_fmac_f32 v213, v211, v210
    v_mul_f32 v206, v212, v212
    v_mul_f32 v207, v212, v213
    v_fma_f32 v206, -v213, v213, v206
    v_fmac_f32 v207, v213, v212
    s_mul_i32 s32, s32, 0x9E3779B1
    s_add_u32 s32, s32, 0x7F4A7C15
    s_xor_b32 s33, s32, 0x5BD1E995
    s_waitcnt vmcnt(7) lgkmcnt(0)
    s_barrier
    ds_read_b128 v[104:107], v224 offset:0
    ds_read_b128 v[108:111], v225 offset:0
    ds_read_b128 v[112:115], v226 offset:0
    ds_read_b128 v[116:119], v227 offset:0
    s_add_u32 s74, s75, 0
    s_and_b32 s74, s74, 7
    s_add_u32 m0, s77, 0
    s_lshl_b32 s72, s74, 7
    buffer_load_dwordx4 v247, s[20:23], s72 offen offset:0 lds
    buffer_load_dwordx4 v248, s[20:23], s72 offen offset:1024 lds
    buffer_load_dwordx4 v249, s[20:23], s72 offen offset:2048 lds
    buffer_load_dwordx4 v250, s[20:23], s72 offen offset:3072 lds
    v_mul_f32 v210, v204, v204
    v_mul_f32 v211, v204, v205
    v_fma_f32 v210, -v205, v205, v210
    v_fmac_f32 v211, v205, v204
    v_mul_f32 v212, v210, v210
    v_mul_f32 v213, v210, v211
    v_fma_f32 v212, -v211, v211, v212
    v_fmac_f32 v213, v211, v210
    v_cmp_lt_u32 vcc, 31, v0
    s_bitcmp1_b32 s4, 0
    s_cselect_b64 s[78:79], -1, 0
    v_cndmask_b32 v214, 1.0, v204, vcc
    v_cndmask_b32 v215, 0, v205, vcc
    v_cndmask_b32 v210, 1.0, v210, s[78:79]
    v_cndmask_b32 v211, 0, v211, s[78:79]
    s_bitcmp1_b32 s4, 1
    s_cselect_b64 s[78:79], -1, 0
    v_mul_f32 v216, v214, v210
    v_mul_f32 v217, v214, v211
    v_fma_f32 v216, -v215, v211, v216
    v_fmac_f32 v217, v215, v210
    v_cndmask_b32 v212, 1.0, v212, s[78:79]
    v_cndmask_b32 v213, 0, v213, s[78:79]
    v_mul_f32 v220, v216, v212
    v_mul_f32 v221, v216, v213
    v_fma_f32 v220, -v217, v213, v220
    v_fmac_f32 v221, v217, v212
    s_mul_i32 s68, s4, 2560
    s_add_u32 s68, s68, 151552
    v_mul_u32_u24 v4, 80, v2
    v_lshl_add_u32 v4, v1, 5, v4
    v_add_u32 v222, s68, v4
    v_bfe_u32 v4, v0, 2, 2
    v_lshl_add_u32 v4, v1, 3, v4
    v_mul_u32_u24 v4, 80, v4
    v_and_b32 v5, 1, v0
    v_lshl_add_u32 v4, v5, 5, v4
    v_bfe_u32 v5, v0, 4, 1
    v_lshl_add_u32 v4, v5, 4, v4
    v_bfe_u32 v5, v0, 1, 1
    v_lshl_add_u32 v4, v5, 3, v4
    v_add_u32 v223, s68, v4
    v_add_f32 v202, v202, v202
    v_add_f32 v203, v203, v203
    s_waitcnt vmcnt(4) lgkmcnt(0)
    s_barrier
    ds_read_b128 v[120:123], v224 offset:4096
    ds_read_b128 v[124:127], v225 offset:4096
    ds_read_b128 v[128:131], v226 offset:4096
    ds_read_b128 v[132:135], v227 offset:4096
    s_waitcnt lgkmcnt(0)
    s_barrier
    s_setprio 1
    s_add_u32 s74, s75, 2
    s_and_b32 s74, s74, 7
    s_add_u32 m0, s77, 8192
    s_lshl_b32 s72, s74, 7
    buffer_load_dwordx4 v247, s[20:23], s72 offen offset:0 lds
    buffer_load_dwordx4 v248, s[20:23], s72 offen offset:1024 lds
    buffer_load_dwordx4 v249, s[20:23], s72 offen offset:2048 lds
    buffer_load_dwordx4 v250, s[20:23], s72 offen offset:3072 lds
    s_add_u32 s74, s75, 4
    s_and_b32 s74, s74, 7
    s_add_u32 m0, s77, 16384
    s_lshl_b32 s72, s74, 7
    buffer_load_dwordx4 v247, s[20:23], s72 offen offset:0 lds
    buffer_load_dwordx4 v248, s[20:23], s72 offen offset:1024 lds
    buffer_load_dwordx4 v249, s[20:23], s72 offen offset:2048 lds
    buffer_load_dwordx4 v250, s[20:23], s72 offen offset:3072 lds
    s_add_u32 s74, s75, 6
    s_and_b32 s74, s74, 7
    s_add_u32 m0, s77, 24576
    s_lshl_b32 s72, s74, 7
    buffer_load_dwordx4 v247, s[20:23], s72 offen offset:0 lds
    buffer_load_dwordx4 v248, s[20:23], s72 offen offset:1024 lds
    buffer_load_dwordx4 v249, s[20:23], s72 offen offset:2048 lds
    buffer_load_dwordx4 v250, s[20:23], s72 offen offset:3072 lds
    v_mov_b32 v160, 161796
    v_mov_b32 v162, 161804
    v_mov_b32 v161, -1
    s_waitcnt vmcnt(8)
    s_mov_b64 exec, 1
    ds_inc_u32 v160, v161
    s_mov_b64 exec, -1
    s_mov_b32 s81, 3200000
Lspin5:
    ds_read_b32 v6, v160
    s_sub_u32 s81, s81, 1
    s_cbranch_scc1 Lspinx5
    s_waitcnt lgkmcnt(0)
    v_cmp_ne_u32 s[78:79], 4, v6
    s_nop 0
    s_cmp_eq_u64 s[78:79], 0
    s_cbranch_scc1 Lspinx5
    s_sleep 1
    s_branch Lspin5
Lspinx5:
    s_waitcnt lgkmcnt(0)
    ds_read_b128 v[136:139], v228 offset:0
    ds_read_b128 v[140:143], v228 offset:32768
    ds_read_b128 v[144:147], v229 offset:0
    ds_read_b128 v[148:151], v229 offset:32768
    ds_read_b128 v[152:155], v230 offset:0
    ds_read_b128 v[156:159], v230 offset:32768
    s_waitcnt lgkmcnt(4)
    v_mfma_f32_32x32x16_bf16 v[168:183], v[8:11], v[136:139], 0
    v_mfma_f32_32x32x16_bf16 v[184:199], v[8:11], v[140:143], 0
    ds_read_b128 v[136:139], v231 offset:0
    ds_read_b128 v[140:143], v231 offset:32768
    s_waitcnt lgkmcnt(4)
    v_mfma_f32_32x32x16_bf16 v[168:183], v[12:15], v[144:147], v[168:183]
    v_mfma_f32_32x32x16_bf16 v[184:199], v[12:15], v[148:151], v[184:199]
    ds_read_b128 v[144:147], v228 offset:4096
    ds_read_b128 v[148:151], v228 offset:36864
    s_waitcnt lgkmcnt(4)
    v_mfma_f32_32x32x16_bf16 v[168:183], v[16:19], v[152:155], v[168:183]
    v_mfma_f32_32x32x16_bf16 v[184:199], v[16:19], v[156:159], v[184:199]
    ds_read_b128 v[152:155], v229 offset:4096
    ds_read_b128 v[156:159], v229 offset:36864
    s_waitcnt lgkmcnt(4)
    v_mfma_f32_32x32x16_bf16 v[168:183], v[20:23], v[136:139], v[168:183]
    v_mfma_f32_32x32x16_bf16 v[184:199], v[20:23], v[140:143], v[184:199]
    ds_read_b128 v[136:139], v230 offset:4096
    ds_read_b128 v[140:143], v230 offset:36864
    s_waitcnt lgkmcnt(4)
    v_mfma_f32_32x32x16_bf16 v[168:183], v[24:27], v[144:147], v[168:183]
    v_mfma_f32_32x32x16_bf16 v[184:199], v[24:27], v[148:151], v[184:199]
    ds_read_b128 v[144:147], v231 offset:4096
    ds_read_b128 v[148:151], v231 offset:36864
    s_waitcnt lgkmcnt(4)
    v_mfma_f32_32x32x16_bf16 v[168:183], v[28:31], v[152:155], v[168:183]
    v_mfma_f32_32x32x16_bf16 v[184:199], v[28:31], v[156:159], v[184:199]
    ds_read_b128 v[152:155], v228 offset:8192
    ds_read_b128 v[156:159], v228 offset:40960
    s_waitcnt lgkmcnt(4)
    v_mfma_f32_32x32x16_bf16 v[168:183], v[32:35], v[136:139], v[168:183]
    v_mfma_f32_32x32x16_bf16 v[184:199], v[32:35], v[140:143], v[184:199]
    ds_read_b128 v[136:139], v229 offset:8192
    ds_read_b128 v[140:143], v229 offset:40960
    s_waitcnt lgkmcnt(4)
    v_mfma_f32_32x32x16_bf16 v[168:183], v[36:39], v[144:147], v[168:183]
    v_mfma_f32_32x32x16_bf16 v[184:199], v[36:39], v[148:151], v[184:199]
    ds_read_b128 v[144:147], v230 offset:8192
    ds_read_b128 v[148:151], v230 offset:40960
    s_waitcnt lgkmcnt(4)
    v_mfma_f32_32x32x16_bf16 v[168:183], v[40:43], v[152:155], v[168:183]
    v_mfma_f32_32x32x16_bf16 v[184:199], v[40:43], v[156:159], v[184:199]
    ds_read_b128 v[152:155], v231 offset:8192
    ds_read_b128 v[156:159], v231 offset:40960
    s_waitcnt lgkmcnt(4)
    v_mfma_f32_32x32x16_bf16 v[168:183], v[44:47], v[136:139], v[168:183]
    v_mfma_f32_32x32x16_bf16 v[184:199], v[44:47], v[140:143], v[184:199]
    ds_read_b128 v[136:139], v228 offset:12288
    ds_read_b128 v[140:143], v228 offset:45056
    s_waitcnt lgkmcnt(4)
    v_mfma_f32_32x32x16_bf16 v[168:183], v[48:51], v[144:147], v[168:183]
    v_mfma_f32_32x32x16_bf16 v[184:199], v[48:51], v[148:151], v[184:199]
    ds_read_b128 v[144:147], v229 offset:12288
    ds_read_b128 v[148:151], v229 offset:45056
    s_waitcnt lgkmcnt(4)
    v_mfma_f32_32x32x16_bf16 v[168:183], v[52:55], v[152:155], v[168:183]
    v_mfma_f32_32x32x16_bf16 v[184:199], v[52:55], v[156:159], v[184:199]
    ds_read_b128 v[152:155], v230 offset:12288
    ds_read_b128 v[156:159], v230 offset:45056
    s_waitcnt lgkmcnt(4)
    v_mfma_f32_32x32x16_bf16 v[168:183], v[56:59], v[136:139], v[168:183]
    v_mfma_f32_32x32x16_bf16 v[184:199], v[56:59], v[140:143], v[184:199]
    ds_read_b128 v[136:139], v231 offset:12288
    ds_read_b128 v[140:143], v231 offset:45056
    s_waitcnt lgkmcnt(4)
    v_mfma_f32_32x32x16_bf16 v[168:183], v[60:63], v[144:147], v[168:183]
    v_mfma_f32_32x32x16_bf16 v[184:199], v[60:63], v[148:151], v[184:199]
    s_waitcnt vmcnt(0)
    s_mov_b64 exec, 1
    ds_inc_u32 v162, v161
    s_mov_b64 exec, -1
    s_mov_b32 s81, 3200000
Lspin6:
    ds_read_b32 v6, v162
    s_sub_u32 s81, s81, 1
    s_cbranch_scc1 Lspinx6
    s_waitcnt lgkmcnt(0)
    v_cmp_ne_u32 s[78:79], 4, v6
    s_nop 0
    s_cmp_eq_u64 s[78:79], 0
    s_cbranch_scc1 Lspinx6
    s_sleep 1
    s_branch Lspin6
Lspinx6:
    s_waitcnt lgkmcnt(0)
    ds_read_b128 v[144:147], v228 offset:16384
    ds_read_b128 v[148:151], v228 offset:49152
    s_waitcnt lgkmcnt(4)
    v_mfma_f32_32x32x16_bf16 v[168:183], v[64:67], v[152:155], v[168:183]
    v_mfma_f32_32x32x16_bf16 v[184:199], v[64:67], v[156:159], v[184:199]
    ds_read_b128 v[152:155], v229 offset:16384
    ds_read_b128 v[156:159], v229 offset:49152
    s_waitcnt lgkmcnt(4)
    v_mfma_f32_32x32x16_bf16 v[168:183], v[68:71], v[136:139], v[168:183]
    v_mfma_f32_32x32x16_bf16 v[184:199], v[68:71], v[140:143], v[184:199]
    ds_read_b128 v[136:139], v230 offset:16384
    ds_read_b128 v[140:143], v230 offset:49152
    s_waitcnt lgkmcnt(4)
    v_mfma_f32_32x32x16_bf16 v[168:183], v[72:75], v[144:147], v[168:183]
    v_mfma_f32_32x32x16_bf16 v[184:199], v[72:75], v[148:151], v[184:199]
    ds_read_b128 v[144:147], v231 offset:16384
    ds_read_b128 v[148:151], v231 offset:49152
    s_waitcnt lgkmcnt(4)
    v_mfma_f32_32x32x16_bf16 v[168:183], v[76:79], v[152:155], v[168:183]
    v_mfma_f32_32x32x16_bf16 v[184:199], v[76:79], v[156:159], v[184:199]
    ds_read_b128 v[152:155], v228 offset:20480
    ds_read_b128 v[156:159], v228 offset:53248
    s_waitcnt lgkmcnt(4)
    v_mfma_f32_32x32x16_bf16 v[168:183], v[80:83], v[136:139], v[168:183]
    v_mfma_f32_32x32x16_bf16 v[184:199], v[80:83], v[140:143], v[184:199]
    ds_read_b128 v[136:139], v229 offset:20480
    ds_read_b128 v[140:143], v229 offset:53248
    s_waitcnt lgkmcnt(4)
    v_mfma_f32_32x32x16_bf16 v[168:183], v[84:87], v[144:147], v[168:183]
    v_mfma_f32_32x32x16_bf16 v[184:199], v[84:87], v[148:151], v[184:199]
    ds_read_b128 v[144:147], v230 offset:20480
    ds_read_b128 v[148:151], v230 offset:53248
    s_waitcnt lgkmcnt(4)
    v_mfma_f32_32x32x16_bf16 v[168:183], v[88:91], v[152:155], v[168:183]
    v_mfma_f32_32x32x16_bf16 v[184:199], v[88:91], v[156:159], v[184:199]
    ds_read_b128 v[152:155], v231 offset:20480
    ds_read_b128 v[156:159], v231 offset:53248
    s_waitcnt lgkmcnt(4)
    v_mfma_f32_32x32x16_bf16 v[168:183], v[92:95], v[136:139], v[168:183]
    v_mfma_f32_32x32x16_bf16 v[184:199], v[92:95], v[140:143], v[184:199]
    ds_read_b128 v[136:139], v228 offset:24576
    ds_read_b128 v[140:143], v228 offset:57344
    s_waitcnt lgkmcnt(4)
    v_mfma_f32_32x32x16_bf16 v[168:183], v[96:99], v[144:147], v[168:183]
    v_mfma_f32_32x32x16_bf16 v[184:199], v[96:99], v[148:151], v[184:199]
    ds_read_b128 v[144:147], v229 offset:24576
    ds_read_b128 v[148:151], v229 offset:57344
    s_waitcnt lgkmcnt(4)
    v_mfma_f32_32x32x16_bf16 v[168:183], v[100:103], v[152:155], v[168:183]
    v_mfma_f32_32x32x16_bf16 v[184:199], v[100:103], v[156:159], v[184:199]
    ds_read_b128 v[152:155], v230 offset:24576
    ds_read_b128 v[156:159], v230 offset:57344
    s_waitcnt lgkmcnt(4)
    v_mfma_f32_32x32x16_bf16 v[168:183], v[104:107], v[136:139], v[168:183]
    v_mfma_f32_32x32x16_bf16 v[184:199], v[104:107], v[140:143], v[184:199]
    ds_read_b128 v[136:139], v231 offset:24576
    ds_read_b128 v[140:143], v231 offset:57344
    s_waitcnt lgkmcnt(4)
    v_mfma_f32_32x32x16_bf16 v[168:183], v[108:111], v[144:147], v[168:183]
    v_mfma_f32_32x32x16_bf16 v[184:199], v[108:111], v[148:151], v[184:199]
    ds_read_b128 v[144:147], v228 offset:28672
    ds_read_b128 v[148:151], v228 offset:61440
    s_waitcnt lgkmcnt(4)
    v_mfma_f32_32x32x16_bf16 v[168:183], v[112:115], v[152:155], v[168:183]
    v_mfma_f32_32x32x16_bf16 v[184:199], v[112:115], v[156:159], v[184:199]
    ds_read_b128 v[152:155], v229 offset:28672
    ds_read_b128 v[156:159], v229 offset:61440
    s_waitcnt lgkmcnt(4)
    v_mfma_f32_32x32x16_bf16 v[168:183], v[116:119], v[136:139], v[168:183]
    v_mfma_f32_32x32x16_bf16 v[184:199], v[116:119], v[140:143], v[184:199]
    ds_read_b128 v[136:139], v230 offset:28672
    ds_read_b128 v[140:143], v230 offset:61440
    s_waitcnt lgkmcnt(4)
    v_mfma_f32_32x32x16_bf16 v[168:183], v[120:123], v[144:147], v[168:183]
    v_mfma_f32_32x32x16_bf16 v[184:199], v[120:123], v[148:151], v[184:199]
    ds_read_b128 v[144:147], v231 offset:28672
    ds_read_b128 v[148:151], v231 offset:61440
    s_waitcnt lgkmcnt(4)
    v_mfma_f32_32x32x16_bf16 v[168:183], v[124:127], v[152:155], v[168:183]
    v_mfma_f32_32x32x16_bf16 v[184:199], v[124:127], v[156:159], v[184:199]
    s_waitcnt lgkmcnt(2)
    v_mfma_f32_32x32x16_bf16 v[168:183], v[128:131], v[136:139], v[168:183]
    v_mfma_f32_32x32x16_bf16 v[184:199], v[128:131], v[140:143], v[184:199]
    s_waitcnt lgkmcnt(0)
    v_mfma_f32_32x32x16_bf16 v[168:183], v[132:135], v[144:147], v[168:183]
    v_mfma_f32_32x32x16_bf16 v[184:199], v[132:135], v[148:151], v[184:199]
    s_lshl_b32 s68, s4, 9
    s_add_u32 s68, s68, 74752
    v_lshl_add_u32 v18, v0, 3, s68
    v_lshlrev_b32 v19, 3, v2
    v_add_u32 v19, 74752, v19
    v_mov_b32 v21, 161792
    v_mov_b32 v22, -1
    s_nop 3
    v_fma_f32 v210, v200, v168, v169
    v_fma_f32 v211, v200, v184, v185
    v_fma_f32 v210, -v201, v184, v210
    v_fmac_f32 v211, v201, v168
    v_fma_f32 v212, v200, v210, v170
    v_fma_f32 v213, v200, v211, v186
    v_fma_f32 v212, -v201, v211, v212
    v_fmac_f32 v213, v201, v210
    v_fma_f32 v210, v200, v212, v171
    v_fma_f32 v211, v200, v213, v187
    v_fma_f32 v210, -v201, v213, v210
    v_fmac_f32 v211, v201, v212
    v_fma_f32 v212, v200, v210, v172
    v_fma_f32 v213, v200, v211, v188
    v_fma_f32 v212, -v201, v211, v212
    v_fmac_f32 v213, v201, v210
    v_fma_f32 v210, v200, v212, v173
    v_fma_f32 v211, v200, v213, v189
    v_fma_f32 v210, -v201, v213, v210
    v_fmac_f32 v211, v201, v212
    v_fma_f32 v212, v200, v210, v174
    v_fma_f32 v213, v200, v211, v190
    v_fma_f32 v212, -v201, v211, v212
    v_fmac_f32 v213, v201, v210
    v_fma_f32 v210, v200, v212, v175
    v_fma_f32 v211, v200, v213, v191
    v_fma_f32 v210, -v201, v213, v210
    v_fmac_f32 v211, v201, v212
    v_fma_f32 v212, v200, v210, v176
    v_fma_f32 v213, v200, v211, v192
    v_fma_f32 v212, -v201, v211, v212
    v_fmac_f32 v213, v201, v210
    v_fma_f32 v210, v200, v212, v177
    v_fma_f32 v211, v200, v213, v193
    v_fma_f32 v210, -v201, v213, v210
    v_fmac_f32 v211, v201, v212
    v_fma_f32 v212, v200, v210, v178
    v_fma_f32 v213, v200, v211, v194
    v_fma_f32 v212, -v201, v211, v212
    v_fmac_f32 v213, v201, v210
    v_fma_f32 v210, v200, v212, v179
    v_fma_f32 v211, v200, v213, v195
    v_fma_f32 v210, -v201, v213, v210
    v_fmac_f32 v211, v201, v212
    v_fma_f32 v212, v200, v210, v180
    v_fma_f32 v213, v200, v211, v196
    v_fma_f32 v212, -v201, v211, v212
    v_fmac_f32 v213, v201, v210
    v_fma_f32 v210, v200, v212, v181
    v_fma_f32 v211, v200, v213, v197
    v_fma_f32 v210, -v201, v213, v210
    v_fmac_f32 v211, v201, v212
    v_fma_f32 v212, v200, v210, v182
    v_fma_f32 v213, v200, v211, v198
    v_fma_f32 v212, -v201, v211, v212
    v_fmac_f32 v213, v201, v210
    v_fma_f32 v210, v200, v212, v183
    v_fma_f32 v211, v200, v213, v199
    v_fma_f32 v210, -v201, v213, v210
    v_fmac_f32 v211, v201, v212
    ds_write_b64 v18, v[210:211]
    s_waitcnt lgkmcnt(0)
    s_mov_b64 exec, 1
    ds_inc_u32 v21, v22
    s_mov_b64 exec, -1
    s_mov_b32 s81, 3200000
Lspin7:
    ds_read_b32 v6, v21
    s_sub_u32 s81, s81, 1
    s_cbranch_scc1 Lspinx7
    s_waitcnt lgkmcnt(0)
    v_cmp_ne_u32 s[78:79], 4, v6
    s_nop 0
    s_cmp_eq_u64 s[78:79], 0
    s_cbranch_scc1 Lspinx7
    s_sleep 1
    s_branch Lspin7
Lspinx7:
    s_waitcnt lgkmcnt(0)
    ds_read_b64 v[136:137], v19 offset:0
    ds_read_b64 v[138:139], v19 offset:256
    ds_read_b64 v[140:141], v19 offset:512
    ds_read_b64 v[142:143], v19 offset:768
    ds_read_b64 v[144:145], v19 offset:1024
    ds_read_b64 v[146:147], v19 offset:1280
    ds_read_b64 v[148:149], v19 offset:1536
    ds_read_b64 v[150:151], v19 offset:1792
    s_lshl_b32 s69, s37, 3
    s_lshl_b32 s68, s4, 1
    s_add_u32 s69, s69, s68
    s_add_u32 s46, s69, s5
    s_lshl_b32 s76, s36, 16
    s_lshl_b32 s77, s69, 10
    s_add_u32 s77, s77, s76
    s_mul_i32 s72, s5, 86016
    s_mov_b32 s44, 0xffff
    s_mov_b32 s45, 0xffff
    s_lshl_b32 s49, s38, 1
    s_add_u32 s49, s49, s5
    s_lshl_b32 s73, s5, 15
    s_add_u32 s73, s73, s76
    s_add_u32 s73, s73, 2097152
    s_lshl_b32 s62, s37, 2
    s_lshl_b32 s69, s4, 1
    s_add_u32 s62, s62, s69
    s_lshl_b32 s63, s4, 12
    s_add_u32 s63, s63, s72
    s_and_b32 s74, s62, 31
    s_lshl_b32 s74, s74, 10
    s_add_u32 s74, s74, s73
    v_mov_b32 v5, 161844
    s_mov_b32 s81, 3200000
Lspin8:
    ds_read_b32 v6, v5
    s_sub_u32 s81, s81, 1
    s_cbranch_scc1 Lspinx8
    s_waitcnt lgkmcnt(0)
    v_cmp_ne_u32 s[78:79], 1, v6
    s_nop 0
    s_cmp_eq_u64 s[78:79], 0
    s_cbranch_scc1 Lspinx8
    s_sleep 1
    s_branch Lspin8
Lspinx8:
    s_waitcnt lgkmcnt(0)
    buffer_load_dwordx4 v[72:75], v3, s[12:15], s77 offen offset:0 sc1
    buffer_load_dwordx4 v[76:79], v3, s[12:15], s77 offen offset:1024 sc1
    s_mov_b32 m0, s63
    s_add_u32 s70, s74, 2096128
    buffer_load_dwordx4 v3, s[12:15], s74 offen sc1 lds
    buffer_load_dwordx4 v3, s[12:15], s70 offen offset:1024 sc1 lds
    s_sub_u32 s71, s74, 1024
    s_sub_u32 s70, s70, 1024
    buffer_load_dwordx4 v3, s[12:15], s71 offen offset:2048 sc1 lds
    buffer_load_dwordx4 v3, s[12:15], s70 offen offset:3072 sc1 lds
    v_mov_b64 v[216:217], 0
    v_mov_b64 v[218:219], 0
    s_lshl_b32 s68, s4, 1
    s_cmp_eq_u32 s4, 0
    v_pk_fma_f32 v[138:139], v[136:137], v[204:205], v[138:139] op_sel:[0,0,0] op_sel_hi:[1,0,1]
    s_cbranch_scc0 Lcs9
    v_mov_b64 v[218:219], v[136:137]
Lcs9:
    v_pk_fma_f32 v[210:211], v[136:137], v[204:205], v[138:139] op_sel:[1,1,0] op_sel_hi:[0,1,1] neg_lo:[0,1,0]
    s_cmp_eq_u32 s4, 1
    v_pk_fma_f32 v[140:141], v[210:211], v[204:205], v[140:141] op_sel:[0,0,0] op_sel_hi:[1,0,1]
    s_cbranch_scc0 Lcs10
    v_mov_b64 v[216:217], v[210:211]
Lcs10:
    v_pk_fma_f32 v[212:213], v[210:211], v[204:205], v[140:141] op_sel:[1,1,0] op_sel_hi:[0,1,1] neg_lo:[0,1,0]
    s_cmp_eq_u32 s4, 1
    v_pk_fma_f32 v[142:143], v[212:213], v[204:205], v[142:143] op_sel:[0,0,0] op_sel_hi:[1,0,1]
    s_cbranch_scc0 Lcs11
    v_mov_b64 v[218:219], v[212:213]
Lcs11:
    v_pk_fma_f32 v[210:211], v[212:213], v[204:205], v[142:143] op_sel:[1,1,0] op_sel_hi:[0,1,1] neg_lo:[0,1,0]
    s_cmp_eq_u32 s4, 2
    v_pk_fma_f32 v[144:145], v[210:211], v[204:205], v[144:145] op_sel:[0,0,0] op_sel_hi:[1,0,1]
    s_cbranch_scc0 Lcs12
    v_mov_b64 v[216:217], v[210:211]
Lcs12:
    v_pk_fma_f32 v[212:213], v[210:211], v[204:205], v[144:145] op_sel:[1,1,0] op_sel_hi:[0,1,1] neg_lo:[0,1,0]
    s_cmp_eq_u32 s4, 2
    v_pk_fma_f32 v[146:147], v[212:213], v[204:205], v[146:147] op_sel:[0,0,0] op_sel_hi:[1,0,1]
    s_cbranch_scc0 Lcs13
    v_mov_b64 v[218:219], v[212:213]
Lcs13:
    v_pk_fma_f32 v[210:211], v[212:213], v[204:205], v[146:147] op_sel:[1,1,0] op_sel_hi:[0,1,1] neg_lo:[0,1,0]
    s_cmp_eq_u32 s4, 3
    v_pk_fma_f32 v[148:149], v[210:211], v[204:205], v[148:149] op_sel:[0,0,0] op_sel_hi:[1,0,1]
    s_cbranch_scc0 Lcs14
    v_mov_b64 v[216:217], v[210:211]
Lcs14:
    v_pk_fma_f32 v[212:213], v[210:211], v[204:205], v[148:149] op_sel:[1,1,0] op_sel_hi:[0,1,1] neg_lo:[0,1,0]
    s_cmp_eq_u32 s4, 3
    v_pk_fma_f32 v[150:151], v[212:213], v[204:205], v[150:151] op_sel:[0,0,0] op_sel_hi:[1,0,1]
    s_cbranch_scc0 Lcs15
    v_mov_b64 v[218:219], v[212:213]
Lcs15:
    v_pk_fma_f32 v[210:211], v[212:213], v[204:205], v[150:151] op_sel:[1,1,0] op_sel_hi:[0,1,1] neg_lo:[0,1,0]
    v_cmp_lt_u32 vcc, 31, v0
    s_lshl_b32 s68, s35, 8
    v_lshl_add_u32 v18, v2, 3, s68
    v_cndmask_b32 v216, v216, v218, vcc
    v_cndmask_b32 v217, v217, v219, vcc
    v_mul_f32 v212, v210, v202
    v_mul_f32 v213, v210, v203
    v_fma_f32 v212, -v211, v203, v212
    v_fmac_f32 v213, v211, v202
    v_mul_f32 v208, v216, v202
    v_mul_f32 v209, v216, v203
    v_fma_f32 v208, -v217, v203, v208
    v_fmac_f32 v209, v217, v202
    s_lshl_b32 s68, s34, 12
    s_add_u32 s68, s68, 14221312
    s_cmp_eq_u32 s4, 0
    s_cbranch_scc0 L_noE
    buffer_store_dwordx2 v[212:213], v18, s[12:15], s68 offen sc1
L_noE:
    v_pk_mul_f32 v[214:215], v[184:185], v[202:203] op_sel:[0,1] op_sel_hi:[1,1]
    v_pk_mul_f32 v[216:217], v[168:169], v[202:203] op_sel:[0,1] op_sel_hi:[1,1]
    v_pk_fma_f32 v[168:169], v[168:169], v[202:203], v[214:215] op_sel:[0,0,0] op_sel_hi:[1,0,1] neg_lo:[0,0,1] neg_hi:[0,0,1]
    v_pk_fma_f32 v[184:185], v[184:185], v[202:203], v[216:217] op_sel:[0,0,0] op_sel_hi:[1,0,1]
    v_pk_mul_f32 v[214:215], v[186:187], v[202:203] op_sel:[0,1] op_sel_hi:[1,1]
    v_pk_mul_f32 v[216:217], v[170:171], v[202:203] op_sel:[0,1] op_sel_hi:[1,1]
    v_pk_fma_f32 v[170:171], v[170:171], v[202:203], v[214:215] op_sel:[0,0,0] op_sel_hi:[1,0,1] neg_lo:[0,0,1] neg_hi:[0,0,1]
    v_pk_fma_f32 v[186:187], v[186:187], v[202:203], v[216:217] op_sel:[0,0,0] op_sel_hi:[1,0,1]
    v_pk_mul_f32 v[214:215], v[188:189], v[202:203] op_sel:[0,1] op_sel_hi:[1,1]
    v_pk_mul_f32 v[216:217], v[172:173], v[202:203] op_sel:[0,1] op_sel_hi:[1,1]
    v_pk_fma_f32 v[172:173], v[172:173], v[202:203], v[214:215] op_sel:[0,0,0] op_sel_hi:[1,0,1] neg_lo:[0,0,1] neg_hi:[0,0,1]
    v_pk_fma_f32 v[188:189], v[188:189], v[202:203], v[216:217] op_sel:[0,0,0] op_sel_hi:[1,0,1]
    v_pk_mul_f32 v[214:215], v[190:191], v[202:203] op_sel:[0,1] op_sel_hi:[1,1]
    v_pk_mul_f32 v[216:217], v[174:175], v[202:203] op_sel:[0,1] op_sel_hi:[1,1]
    v_pk_fma_f32 v[174:175], v[174:175], v[202:203], v[214:215] op_sel:[0,0,0] op_sel_hi:[1,0,1] neg_lo:[0,0,1] neg_hi:[0,0,1]
    v_pk_fma_f32 v[190:191], v[190:191], v[202:203], v[216:217] op_sel:[0,0,0] op_sel_hi:[1,0,1]
    v_pk_mul_f32 v[214:215], v[192:193], v[202:203] op_sel:[0,1] op_sel_hi:[1,1]
    v_pk_mul_f32 v[216:217], v[176:177], v[202:203] op_sel:[0,1] op_sel_hi:[1,1]
    v_pk_fma_f32 v[176:177], v[176:177], v[202:203], v[214:215] op_sel:[0,0,0] op_sel_hi:[1,0,1] neg_lo:[0,0,1] neg_hi:[0,0,1]
    v_pk_fma_f32 v[192:193], v[192:193], v[202:203], v[216:217] op_sel:[0,0,0] op_sel_hi:[1,0,1]
    v_pk_mul_f32 v[214:215], v[194:195], v[202:203] op_sel:[0,1] op_sel_hi:[1,1]
    v_pk_mul_f32 v[216:217], v[178:179], v[202:203] op_sel:[0,1] op_sel_hi:[1,1]
    v_pk_fma_f32 v[178:179], v[178:179], v[202:203], v[214:215] op_sel:[0,0,0] op_sel_hi:[1,0,1] neg_lo:[0,0,1] neg_hi:[0,0,1]
    v_pk_fma_f32 v[194:195], v[194:195], v[202:203], v[216:217] op_sel:[0,0,0] op_sel_hi:[1,0,1]
    v_pk_mul_f32 v[214:215], v[196:197], v[202:203] op_sel:[0,1] op_sel_hi:[1,1]
    v_pk_mul_f32 v[216:217], v[180:181], v[202:203] op_sel:[0,1] op_sel_hi:[1,1]
    v_pk_fma_f32 v[180:181], v[180:181], v[202:203], v[214:215] op_sel:[0,0,0] op_sel_hi:[1,0,1] neg_lo:[0,0,1] neg_hi:[0,0,1]
    v_pk_fma_f32 v[196:197], v[196:197], v[202:203], v[216:217] op_sel:[0,0,0] op_sel_hi:[1,0,1]
    v_pk_mul_f32 v[214:215], v[198:199], v[202:203] op_sel:[0,1] op_sel_hi:[1,1]
    v_pk_mul_f32 v[216:217], v[182:183], v[202:203] op_sel:[0,1] op_sel_hi:[1,1]
    v_pk_fma_f32 v[182:183], v[182:183], v[202:203], v[214:215] op_sel:[0,0,0] op_sel_hi:[1,0,1] neg_lo:[0,0,1] neg_hi:[0,0,1]
    v_pk_fma_f32 v[198:199], v[198:199], v[202:203], v[216:217] op_sel:[0,0,0] op_sel_hi:[1,0,1]
    v_mov_b64 v[204:205], v[220:221]
    v_mov_b64 v[202:203], v[222:223]
    v_lshrrev_b32 v4, 5, v0
    v_and_b32 v5, 15, v0
    v_lshlrev_b32 v5, 4, v5
    v_lshl_add_u32 v5, v4, 8, v5
    v_add_u32 v2, s72, v5
    v_add_u32 v250, s72, v3
    s_lshl_b32 s68, s4, 4
    s_lshl_b32 s69, s5, 2
    s_add_u32 s68, s68, s69
    s_add_u32 s68, s68, 161920
    v_mov_b32 v1, s68
    v_and_b32 v4, 27, v0
    v_mov_b32 v5, 0x3f803f80
    v_cmp_eq_u32 vcc, 16, v4
    v_mov_b32 v7, 0xdddddddd
    v_mov_b64 v[32:33], 0
    v_mov_b64 v[34:35], 0
    v_mov_b64 v[36:37], 0
    v_mov_b64 v[38:39], 0
    v_mov_b64 v[40:41], 0
    v_mov_b64 v[42:43], 0
    v_mov_b64 v[44:45], 0
    v_mov_b64 v[46:47], 0
    v_mov_b64 v[48:49], 0
    v_mov_b64 v[50:51], 0
    v_mov_b64 v[52:53], 0
    v_mov_b64 v[54:55], 0
    v_mov_b64 v[56:57], 0
    v_mov_b64 v[58:59], 0
    v_mov_b64 v[60:61], 0
    v_mov_b64 v[62:63], 0
    v_mov_b64 v[64:65], 0
    v_mov_b64 v[66:67], 0
    v_mov_b64 v[68:69], 0
    v_mov_b64 v[70:71], 0
    v_cndmask_b32 v4, 0, v5, vcc
    v_mov_b32 v5, v4
    v_mov_b64 v[88:89], v[4:5]
    v_mov_b64 v[90:91], v[4:5]
    v_mov_b64 v[92:93], v[4:5]
    v_mov_b64 v[94:95], v[4:5]
    v_mov_b64 v[96:97], v[4:5]
    v_mov_b64 v[98:99], v[4:5]
    v_mov_b64 v[100:101], v[4:5]
    v_mov_b64 v[102:103], v[4:5]
    s_lshl_b32 s68, s5, 3
    s_add_u32 s68, s68, 161808
    s_waitcnt vmcnt(1)
    s_cmp_eq_u32 s4, 0
    s_cbranch_scc1 Las16
    s_waitcnt vmcnt(0)
Las16:
    v_mov_b32 v6, s68
    s_mov_b64 exec, 1
    ds_inc_u32 v6, v7
    s_mov_b64 exec, -1
    v_mov_b32 v5, s68
    s_mov_b32 s81, 3200000
Lspin17:
    ds_read_b32 v6, v5
    s_sub_u32 s81, s81, 1
    s_cbranch_scc1 Lspinx17
    s_waitcnt lgkmcnt(0)
    v_cmp_ne_u32 s[78:79], 4, v6
    s_nop 0
    s_cmp_eq_u64 s[78:79], 0
    s_cbranch_scc1 Lspinx17
    s_sleep 1
    s_branch Lspin17
Lspinx17:
    s_waitcnt lgkmcnt(0)
    ds_read_b128 v[80:83], v250 offset:0
    s_mov_b64 exec, s[44:45]
    ds_read_b128 v[88:91], v2 offset:1024
    ds_read_b128 v[92:95], v2 offset:1536
    s_mov_b64 exec, -1
    ds_read_b128 v[84:87], v250 offset:2048
    s_waitcnt lgkmcnt(0)
    v_mfma_f32_32x32x16_bf16 v[8:23], v[80:83], v[72:75], 0
    s_add_u32 s70, s62, 8
    s_and_b32 s70, s70, 31
    s_lshl_b32 s70, s70, 10
    s_add_u32 s70, s70, s73
    s_add_u32 m0, s63, 16384
    s_add_u32 s71, s70, 2096128
    buffer_load_dwordx4 v3, s[12:15], s70 offen sc1 lds
    buffer_load_dwordx4 v3, s[12:15], s71 offen offset:1024 sc1 lds
    s_add_u32 s70, s62, 9
    s_and_b32 s70, s70, 31
    s_lshl_b32 s70, s70, 10
    s_add_u32 s70, s70, s73
    s_add_u32 m0, s63, 18432
    s_add_u32 s71, s70, 2096128
    buffer_load_dwordx4 v3, s[12:15], s70 offen sc1 lds
    buffer_load_dwordx4 v3, s[12:15], s71 offen offset:1024 sc1 lds
    s_nop 3
    s_cmp_eq_u32 s4, 0
    s_cbranch_scc0 L_noEf
    s_lshl_b32 s69, s35, 10
    s_lshl_b32 s70, s34, 6
    s_add_u32 s69, s69, s70
    s_add_u32 s69, s69, 14352384
    s_waitcnt vmcnt(4)
    v_mov_b32 v4, s32
    v_mov_b32 v5, s33
    s_mov_b64 exec, 1
    buffer_store_dwordx2 v[4:5], off, s[12:15], s69 sc1
    s_mov_b64 exec, -1
L_noEf:
L_SCHED:
    v_exp_f32 v8, v8
    v_exp_f32 v9, v9
    v_smfmac_f32_32x32x32_bf16 v[56:71], v[100:103], v[32:39], v7
    s_mov_b64 exec, s[44:45]
    ds_read_b128 v[96:99], v2 offset:3072
    ds_read_b128 v[100:103], v2 offset:3584
    s_mov_b64 exec, -1
    v_exp_f32 v10, v10
    v_exp_f32 v11, v11
    v_exp_f32 v12, v12
    v_mfma_f32_32x32x16_bf16 v[24:39], v[80:83], v[76:79], 0
    ds_read_b128 v[80:83], v250 offset:4096
    v_exp_f32 v13, v13
    v_exp_f32 v14, v14
    v_exp_f32 v15, v15
    v_exp_f32 v16, v16
    v_exp_f32 v17, v17
    v_smfmac_f32_32x32x32_bf16 v[40:55], v[88:91], v[8:15], v7
    v_exp_f32 v18, v18
    v_exp_f32 v19, v19
    v_exp_f32 v20, v20
    v_exp_f32 v21, v21
    v_exp_f32 v22, v22
    v_exp_f32 v23, v23
    v_exp_f32 v24, v24
    v_exp_f32 v25, v25
    v_smfmac_f32_32x32x32_bf16 v[40:55], v[92:95], v[16:23], v7
    s_waitcnt lgkmcnt(0)
    v_exp_f32 v26, v26
    v_exp_f32 v27, v27
    v_exp_f32 v28, v28
    v_mfma_f32_32x32x16_bf16 v[8:23], v[84:87], v[72:75], 0
    s_mov_b64 exec, 1
    ds_inc_u32 v1, v7
    ds_inc_u32 v1, v7 offset:8
    s_mov_b64 exec, -1
    v_exp_f32 v29, v29
    v_exp_f32 v30, v30
    v_exp_f32 v31, v31
    v_exp_f32 v32, v32
    v_exp_f32 v33, v33
    v_smfmac_f32_32x32x32_bf16 v[56:71], v[88:91], v[24:31], v7
    ds_read_b32 v6, v1 offset:4
    v_exp_f32 v34, v34
    v_exp_f32 v35, v35
    v_exp_f32 v36, v36
    v_exp_f32 v37, v37
    v_exp_f32 v38, v38
    v_exp_f32 v39, v39
    v_exp_f32 v8, v8
    v_exp_f32 v9, v9
    v_smfmac_f32_32x32x32_bf16 v[56:71], v[92:95], v[32:39], v7
    s_mov_b64 exec, s[44:45]
    ds_read_b128 v[88:91], v2 offset:5120
    ds_read_b128 v[92:95], v2 offset:5632
    s_mov_b64 exec, -1
    v_exp_f32 v10, v10
    v_exp_f32 v11, v11
    v_exp_f32 v12, v12
    v_mfma_f32_32x32x16_bf16 v[24:39], v[84:87], v[76:79], 0
    ds_read_b128 v[84:87], v250 offset:6144
    v_exp_f32 v13, v13
    v_exp_f32 v14, v14
    v_exp_f32 v15, v15
    v_exp_f32 v16, v16
    v_exp_f32 v17, v17
    v_smfmac_f32_32x32x32_bf16 v[40:55], v[96:99], v[8:15], v7
    v_exp_f32 v18, v18
    v_exp_f32 v19, v19
    v_exp_f32 v20, v20
    v_exp_f32 v21, v21
    v_exp_f32 v22, v22
    v_exp_f32 v23, v23
    v_exp_f32 v24, v24
    v_exp_f32 v25, v25
    v_smfmac_f32_32x32x32_bf16 v[40:55], v[100:103], v[16:23], v7
    s_waitcnt lgkmcnt(0)
    v_exp_f32 v26, v26
    v_exp_f32 v27, v27
    v_exp_f32 v28, v28
    v_mfma_f32_32x32x16_bf16 v[8:23], v[80:83], v[72:75], 0
    v_readfirstlane_b32 s75, v6
    v_exp_f32 v29, v29
    v_exp_f32 v30, v30
    v_exp_f32 v31, v31
    v_exp_f32 v32, v32
    v_exp_f32 v33, v33
    v_smfmac_f32_32x32x32_bf16 v[56:71], v[96:99], v[24:31], v7
    s_cmp_lt_u32 s75, 1
    s_setprio 0
    s_cbranch_scc1 Lpr18
    s_setprio 1
Lpr18:
    v_exp_f32 v34, v34
    v_exp_f32 v35, v35
    v_exp_f32 v36, v36
    v_exp_f32 v37, v37
    v_exp_f32 v38, v38
    v_exp_f32 v39, v39
    s_add_u32 s70, s62, 16
    s_and_b32 s70, s70, 31
    s_lshl_b32 s70, s70, 10
    s_add_u32 s70, s70, s73
    s_add_u32 m0, s63, 32768
    s_add_u32 s71, s70, 2096128
    buffer_load_dwordx4 v3, s[12:15], s70 offen sc1 lds
    buffer_load_dwordx4 v3, s[12:15], s71 offen offset:1024 sc1 lds
    s_add_u32 s70, s62, 17
    s_and_b32 s70, s70, 31
    s_lshl_b32 s70, s70, 10
    s_add_u32 s70, s70, s73
    s_add_u32 m0, s63, 34816
    s_add_u32 s71, s70, 2096128
    buffer_load_dwordx4 v3, s[12:15], s70 offen sc1 lds
    buffer_load_dwordx4 v3, s[12:15], s71 offen offset:1024 sc1 lds
    v_exp_f32 v8, v8
    v_exp_f32 v9, v9
    v_smfmac_f32_32x32x32_bf16 v[56:71], v[100:103], v[32:39], v7
    s_mov_b64 exec, s[44:45]
    ds_read_b128 v[96:99], v2 offset:7168
    ds_read_b128 v[100:103], v2 offset:7680
    s_mov_b64 exec, -1
    v_exp_f32 v10, v10
    v_exp_f32 v11, v11
    v_exp_f32 v12, v12
    v_mfma_f32_32x32x16_bf16 v[24:39], v[80:83], v[76:79], 0
    ds_read_b128 v[80:83], v250 offset:8192
    v_exp_f32 v13, v13
    v_exp_f32 v14, v14
    v_exp_f32 v15, v15
    v_exp_f32 v16, v16
    v_exp_f32 v17, v17
    v_smfmac_f32_32x32x32_bf16 v[40:55], v[88:91], v[8:15], v7
    v_exp_f32 v18, v18
    v_exp_f32 v19, v19
    v_exp_f32 v20, v20
    v_exp_f32 v21, v21
    v_exp_f32 v22, v22
    v_exp_f32 v23, v23
    v_exp_f32 v24, v24
    v_exp_f32 v25, v25
    v_smfmac_f32_32x32x32_bf16 v[40:55], v[92:95], v[16:23], v7
    s_waitcnt lgkmcnt(0)
    v_exp_f32 v26, v26
    v_exp_f32 v27, v27
    v_exp_f32 v28, v28
    v_mfma_f32_32x32x16_bf16 v[8:23], v[84:87], v[72:75], 0
    s_mov_b64 exec, 1
    ds_inc_u32 v1, v7
    ds_inc_u32 v1, v7 offset:8
    s_mov_b64 exec, -1
    v_exp_f32 v29, v29
    v_exp_f32 v30, v30
    v_exp_f32 v31, v31
    v_exp_f32 v32, v32
    v_exp_f32 v33, v33
    v_smfmac_f32_32x32x32_bf16 v[56:71], v[88:91], v[24:31], v7
    ds_read_b32 v6, v1 offset:4
    v_exp_f32 v34, v34
    v_exp_f32 v35, v35
    v_exp_f32 v36, v36
    v_exp_f32 v37, v37
    v_exp_f32 v38, v38
    v_exp_f32 v39, v39
    v_exp_f32 v8, v8
    v_exp_f32 v9, v9
    v_smfmac_f32_32x32x32_bf16 v[56:71], v[92:95], v[32:39], v7
    s_mov_b64 exec, s[44:45]
    ds_read_b128 v[88:91], v2 offset:9216
    ds_read_b128 v[92:95], v2 offset:9728
    s_mov_b64 exec, -1
    v_exp_f32 v10, v10
    v_exp_f32 v11, v11
    v_exp_f32 v12, v12
    v_mfma_f32_32x32x16_bf16 v[24:39], v[84:87], v[76:79], 0
    ds_read_b128 v[84:87], v250 offset:10240
    v_exp_f32 v13, v13
    v_exp_f32 v14, v14
    v_exp_f32 v15, v15
    v_exp_f32 v16, v16
    v_exp_f32 v17, v17
    v_smfmac_f32_32x32x32_bf16 v[40:55], v[96:99], v[8:15], v7
    v_exp_f32 v18, v18
    v_exp_f32 v19, v19
    v_exp_f32 v20, v20
    v_exp_f32 v21, v21
    v_exp_f32 v22, v22
    v_exp_f32 v23, v23
    v_exp_f32 v24, v24
    v_exp_f32 v25, v25
    v_smfmac_f32_32x32x32_bf16 v[40:55], v[100:103], v[16:23], v7
    s_waitcnt lgkmcnt(0)
    v_exp_f32 v26, v26
    v_exp_f32 v27, v27
    v_exp_f32 v28, v28
    v_mfma_f32_32x32x16_bf16 v[8:23], v[80:83], v[72:75], 0
    v_readfirstlane_b32 s75, v6
    v_exp_f32 v29, v29
    v_exp_f32 v30, v30
    v_exp_f32 v31, v31
    v_exp_f32 v32, v32
    v_exp_f32 v33, v33
    v_smfmac_f32_32x32x32_bf16 v[56:71], v[96:99], v[24:31], v7
    s_cmp_lt_u32 s75, 2
    s_setprio 0
    s_cbranch_scc1 Lpr19
    s_setprio 1
Lpr19:
    v_exp_f32 v34, v34
    v_exp_f32 v35, v35
    v_exp_f32 v36, v36
    v_exp_f32 v37, v37
    v_exp_f32 v38, v38
    v_exp_f32 v39, v39
    s_lshl_b32 s68, s5, 3
    s_add_u32 s68, s68, 161812
    s_waitcnt vmcnt(4)
    v_mov_b32 v6, s68
    s_mov_b64 exec, 1
    ds_inc_u32 v6, v7
    s_mov_b64 exec, -1
    s_add_u32 s70, s62, 24
    s_and_b32 s70, s70, 31
    s_lshl_b32 s70, s70, 10
    s_add_u32 s70, s70, s73
    s_add_u32 m0, s63, 49152
    s_add_u32 s71, s70, 2096128
    buffer_load_dwordx4 v3, s[12:15], s70 offen sc1 lds
    buffer_load_dwordx4 v3, s[12:15], s71 offen offset:1024 sc1 lds
    s_add_u32 s70, s62, 25
    s_and_b32 s70, s70, 31
    s_lshl_b32 s70, s70, 10
    s_add_u32 s70, s70, s73
    s_add_u32 m0, s63, 51200
    s_add_u32 s71, s70, 2096128
    buffer_load_dwordx4 v3, s[12:15], s70 offen sc1 lds
    buffer_load_dwordx4 v3, s[12:15], s71 offen offset:1024 sc1 lds
    s_cmp_eq_u32 s5, 0
    s_cbranch_scc0 L_noPL0
    buffer_load_dwordx4 v[232:235], v228, s[20:23], s64 offen
    s_bitcmp1_b32 s4, 0
    s_cbranch_scc1 L_nowo1
    buffer_load_ushort v236, v229, s[16:19], s65 offen offset:0
    buffer_load_ushort v237, v229, s[16:19], s65 offen offset:1024
    buffer_load_ushort v238, v229, s[16:19], s65 offen offset:2048
    buffer_load_ushort v239, v229, s[16:19], s65 offen offset:3072
    buffer_load_ushort v240, v230, s[16:19], s65 offen offset:0
    buffer_load_ushort v241, v230, s[16:19], s65 offen offset:1024
    buffer_load_ushort v242, v230, s[16:19], s65 offen offset:2048
    buffer_load_ushort v243, v230, s[16:19], s65 offen offset:3072
L_nowo1:
L_noPL0:
    s_cmp_eq_u32 s5, 1
    s_cbranch_scc0 L_noE3a1
    v_min_u32 v6, 15, v0
    v_cmp_le_u32 s[42:43], s34, v6
    v_lshlrev_b32 v6, 6, v6
    s_lshl_b32 s48, s35, 10
    s_add_u32 s48, s48, 14352384
    buffer_load_dwordx2 v[4:5], v6, s[12:15], s48 offen sc1
L_noE3a1:
    v_exp_f32 v8, v8
    v_exp_f32 v9, v9
    v_smfmac_f32_32x32x32_bf16 v[56:71], v[100:103], v[32:39], v7
    s_mov_b64 exec, s[44:45]
    ds_read_b128 v[96:99], v2 offset:11264
    ds_read_b128 v[100:103], v2 offset:11776
    s_mov_b64 exec, -1
    v_exp_f32 v10, v10
    v_exp_f32 v11, v11
    v_exp_f32 v12, v12
    v_mfma_f32_32x32x16_bf16 v[24:39], v[80:83], v[76:79], 0
    ds_read_b128 v[80:83], v250 offset:12288
    v_exp_f32 v13, v13
    v_exp_f32 v14, v14
    v_exp_f32 v15, v15
    v_exp_f32 v16, v16
    v_exp_f32 v17, v17
    v_smfmac_f32_32x32x32_bf16 v[40:55], v[88:91], v[8:15], v7
    v_exp_f32 v18, v18
    v_exp_f32 v19, v19
    v_exp_f32 v20, v20
    v_exp_f32 v21, v21
    v_exp_f32 v22, v22
    v_exp_f32 v23, v23
    v_exp_f32 v24, v24
    v_exp_f32 v25, v25
    v_smfmac_f32_32x32x32_bf16 v[40:55], v[92:95], v[16:23], v7
    s_waitcnt lgkmcnt(0)
    v_exp_f32 v26, v26
    v_exp_f32 v27, v27
    v_exp_f32 v28, v28
    v_mfma_f32_32x32x16_bf16 v[8:23], v[84:87], v[72:75], 0
    s_mov_b64 exec, 1
    ds_inc_u32 v1, v7
    ds_inc_u32 v1, v7 offset:8
    s_mov_b64 exec, -1
    v_exp_f32 v29, v29
    v_exp_f32 v30, v30
    v_exp_f32 v31, v31
    v_exp_f32 v32, v32
    v_exp_f32 v33, v33
    v_smfmac_f32_32x32x32_bf16 v[56:71], v[88:91], v[24:31], v7
    ds_read_b32 v6, v1 offset:4
    v_exp_f32 v34, v34
    v_exp_f32 v35, v35
    v_exp_f32 v36, v36
    v_exp_f32 v37, v37
    v_exp_f32 v38, v38
    v_exp_f32 v39, v39
    v_exp_f32 v8, v8
    v_exp_f32 v9, v9
    v_smfmac_f32_32x32x32_bf16 v[56:71], v[92:95], v[32:39], v7
    s_mov_b64 exec, s[44:45]
    ds_read_b128 v[88:91], v2 offset:13312
    ds_read_b128 v[92:95], v2 offset:13824
    s_mov_b64 exec, -1
    v_exp_f32 v10, v10
    v_exp_f32 v11, v11
    v_exp_f32 v12, v12
    v_mfma_f32_32x32x16_bf16 v[24:39], v[84:87], v[76:79], 0
    ds_read_b128 v[84:87], v250 offset:14336
    v_exp_f32 v13, v13
    v_exp_f32 v14, v14
    v_exp_f32 v15, v15
    v_exp_f32 v16, v16
    v_exp_f32 v17, v17
    v_smfmac_f32_32x32x32_bf16 v[40:55], v[96:99], v[8:15], v7
    v_exp_f32 v18, v18
    v_exp_f32 v19, v19
    v_exp_f32 v20, v20
    v_exp_f32 v21, v21
    v_exp_f32 v22, v22
    v_exp_f32 v23, v23
    v_exp_f32 v24, v24
    v_exp_f32 v25, v25
    v_smfmac_f32_32x32x32_bf16 v[40:55], v[100:103], v[16:23], v7
    s_waitcnt lgkmcnt(0)
    v_exp_f32 v26, v26
    v_exp_f32 v27, v27
    v_exp_f32 v28, v28
    v_mfma_f32_32x32x16_bf16 v[8:23], v[80:83], v[72:75], 0
    v_readfirstlane_b32 s75, v6
    v_exp_f32 v29, v29
    v_exp_f32 v30, v30
    v_exp_f32 v31, v31
    v_exp_f32 v32, v32
    v_exp_f32 v33, v33
    v_smfmac_f32_32x32x32_bf16 v[56:71], v[96:99], v[24:31], v7
    s_cmp_lt_u32 s75, 3
    s_setprio 0
    s_cbranch_scc1 Lpr20
    s_setprio 1
Lpr20:
    v_exp_f32 v34, v34
    v_exp_f32 v35, v35
    v_exp_f32 v36, v36
    v_exp_f32 v37, v37
    v_exp_f32 v38, v38
    v_exp_f32 v39, v39
    s_lshl_b32 s68, s5, 3
    s_add_u32 s68, s68, 161812
    v_mov_b32 v251, s68
    s_mov_b32 s81, 3200000
Lspin21:
    ds_read_b32 v6, v251
    s_sub_u32 s81, s81, 1
    s_cbranch_scc1 Lspinx21
    s_waitcnt lgkmcnt(0)
    v_cmp_ne_u32 s[78:79], 4, v6
    s_nop 0
    s_cmp_eq_u64 s[78:79], 0
    s_cbranch_scc1 Lspinx21
    s_sleep 1
    s_branch Lspin21
Lspinx21:
    s_waitcnt lgkmcnt(0)
    s_cmp_eq_u32 s5, 1
    s_cbranch_scc0 L_noE3b1
    s_waitcnt vmcnt(0)
    v_cmp_eq_u32 s[78:79], s32, v4
    v_cmp_eq_u32 vcc, s33, v5
    s_nop 0
    s_and_b64 s[78:79], s[78:79], vcc
    s_or_b64 s[78:79], s[78:79], s[42:43]
    s_cmp_eq_u64 s[78:79], -1
    s_cbranch_scc1 Lchk22
    v_min_u32 v6, 15, v0
    v_cmp_le_u32 s[42:43], s34, v6
    v_lshlrev_b32 v6, 6, v6
    s_lshl_b32 s48, s35, 10
    s_add_u32 s48, s48, 14352384
    buffer_load_dwordx2 v[4:5], v6, s[12:15], s48 offen sc1
    s_mov_b32 s81, 400000
Lpoll23:
    buffer_load_dwordx2 v[4:5], v6, s[12:15], s48 offen sc1
    s_sub_u32 s81, s81, 1
    s_cbranch_scc1 Lpollx23
    s_waitcnt vmcnt(0)
    v_cmp_eq_u32 s[78:79], s32, v4
    v_cmp_eq_u32 vcc, s33, v5
    s_nop 0
    s_and_b64 s[78:79], s[78:79], vcc
    s_or_b64 s[78:79], s[78:79], s[42:43]
    s_cmp_eq_u64 s[78:79], -1
    s_cbranch_scc1 Lpollx23
    s_sleep 2
    s_branch Lpoll23
Lpollx23:
    s_waitcnt vmcnt(0)
Lchk22:
    v_and_b32 v6, 31, v0
    s_lshl_b32 s68, s35, 8
    v_lshl_add_u32 v6, v6, 3, s68
    s_mov_b32 s68, 14221312
    s_cmp_le_u32 s34, 0
    s_cbranch_scc1 L_E3bx
    buffer_load_dwordx2 v[210:211], v6, s[12:15], s68 offen sc1
    s_add_u32 s68, s68, 4096
    s_cmp_le_u32 s34, 1
    s_cbranch_scc1 L_E3bx
    buffer_load_dwordx2 v[212:213], v6, s[12:15], s68 offen sc1
    s_add_u32 s68, s68, 4096
    s_cmp_le_u32 s34, 2
    s_cbranch_scc1 L_E3bx
    buffer_load_dwordx2 v[214:215], v6, s[12:15], s68 offen sc1
    s_add_u32 s68, s68, 4096
    s_cmp_le_u32 s34, 3
    s_cbranch_scc1 L_E3bx
    buffer_load_dwordx2 v[216:217], v6, s[12:15], s68 offen sc1
    s_add_u32 s68, s68, 4096
    s_cmp_le_u32 s34, 4
    s_cbranch_scc1 L_E3bx
    buffer_load_dwordx2 v[218:219], v6, s[12:15], s68 offen sc1
    s_add_u32 s68, s68, 4096
    s_cmp_le_u32 s34, 5
    s_cbranch_scc1 L_E3bx
    buffer_load_dwordx2 v[220:221], v6, s[12:15], s68 offen sc1
    s_add_u32 s68, s68, 4096
    s_cmp_le_u32 s34, 6
    s_cbranch_scc1 L_E3bx
    buffer_load_dwordx2 v[222:223], v6, s[12:15], s68 offen sc1
    s_add_u32 s68, s68, 4096
    s_cmp_le_u32 s34, 7
    s_cbranch_scc1 L_E3bx
    buffer_load_dwordx2 v[224:225], v6, s[12:15], s68 offen sc1
    s_add_u32 s68, s68, 4096
    s_cmp_le_u32 s34, 8
    s_cbranch_scc1 L_E3bx
    buffer_load_dwordx2 v[226:227], v6, s[12:15], s68 offen sc1
    s_add_u32 s68, s68, 4096
    s_cmp_le_u32 s34, 9
    s_cbranch_scc1 L_E3bx
    buffer_load_dwordx2 v[228:229], v6, s[12:15], s68 offen sc1
    s_add_u32 s68, s68, 4096
    s_cmp_le_u32 s34, 10
    s_cbranch_scc1 L_E3bx
    buffer_load_dwordx2 v[230:231], v6, s[12:15], s68 offen sc1
    s_add_u32 s68, s68, 4096
    s_cmp_le_u32 s34, 11
    s_cbranch_scc1 L_E3bx
    buffer_load_dwordx2 v[232:233], v6, s[12:15], s68 offen sc1
    s_add_u32 s68, s68, 4096
    s_cmp_le_u32 s34, 12
    s_cbranch_scc1 L_E3bx
    buffer_load_dwordx2 v[234:235], v6, s[12:15], s68 offen sc1
    s_add_u32 s68, s68, 4096
    s_cmp_le_u32 s34, 13
    s_cbranch_scc1 L_E3bx
    buffer_load_dwordx2 v[236:237], v6, s[12:15], s68 offen sc1
    s_add_u32 s68, s68, 4096
    s_cmp_le_u32 s34, 14
    s_cbranch_scc1 L_E3bx
    buffer_load_dwordx2 v[238:239], v6, s[12:15], s68 offen sc1
    s_add_u32 s68, s68, 4096
L_E3bx:
L_noE3b1:
    v_exp_f32 v8, v8
    v_exp_f32 v9, v9
    v_smfmac_f32_32x32x32_bf16 v[56:71], v[100:103], v[32:39], v7
    s_mov_b64 exec, s[44:45]
    ds_read_b128 v[96:99], v2 offset:15360
    ds_read_b128 v[100:103], v2 offset:15872
    s_mov_b64 exec, -1
    v_exp_f32 v10, v10
    v_exp_f32 v11, v11
    v_exp_f32 v12, v12
    v_mfma_f32_32x32x16_bf16 v[24:39], v[80:83], v[76:79], 0
    ds_read_b128 v[80:83], v250 offset:16384
    v_exp_f32 v13, v13
    v_exp_f32 v14, v14
    v_exp_f32 v15, v15
    v_exp_f32 v16, v16
    v_exp_f32 v17, v17
    v_smfmac_f32_32x32x32_bf16 v[40:55], v[88:91], v[8:15], v7
    v_exp_f32 v18, v18
    v_exp_f32 v19, v19
    v_exp_f32 v20, v20
    v_exp_f32 v21, v21
    v_exp_f32 v22, v22
    v_exp_f32 v23, v23
    v_exp_f32 v24, v24
    v_exp_f32 v25, v25
    v_smfmac_f32_32x32x32_bf16 v[40:55], v[92:95], v[16:23], v7
    s_waitcnt lgkmcnt(0)
    v_exp_f32 v26, v26
    v_exp_f32 v27, v27
    v_exp_f32 v28, v28
    v_mfma_f32_32x32x16_bf16 v[8:23], v[84:87], v[72:75], 0
    s_mov_b64 exec, 1
    ds_inc_u32 v1, v7
    ds_inc_u32 v1, v7 offset:8
    s_mov_b64 exec, -1
    v_exp_f32 v29, v29
    v_exp_f32 v30, v30
    v_exp_f32 v31, v31
    v_exp_f32 v32, v32
    v_exp_f32 v33, v33
    v_smfmac_f32_32x32x32_bf16 v[56:71], v[88:91], v[24:31], v7
    ds_read_b32 v6, v1 offset:4
    v_exp_f32 v34, v34
    v_exp_f32 v35, v35
    v_exp_f32 v36, v36
    v_exp_f32 v37, v37
    v_exp_f32 v38, v38
    v_exp_f32 v39, v39
    v_exp_f32 v8, v8
    v_exp_f32 v9, v9
    v_smfmac_f32_32x32x32_bf16 v[56:71], v[92:95], v[32:39], v7
    s_mov_b64 exec, s[44:45]
    ds_read_b128 v[88:91], v2 offset:17408
    ds_read_b128 v[92:95], v2 offset:17920
    s_mov_b64 exec, -1
    v_exp_f32 v10, v10
    v_exp_f32 v11, v11
    v_exp_f32 v12, v12
    v_mfma_f32_32x32x16_bf16 v[24:39], v[84:87], v[76:79], 0
    ds_read_b128 v[84:87], v250 offset:18432
    v_exp_f32 v13, v13
    v_exp_f32 v14, v14
    v_exp_f32 v15, v15
    v_exp_f32 v16, v16
    v_exp_f32 v17, v17
    v_smfmac_f32_32x32x32_bf16 v[40:55], v[96:99], v[8:15], v7
    v_exp_f32 v18, v18
    v_exp_f32 v19, v19
    v_exp_f32 v20, v20
    v_exp_f32 v21, v21
    v_exp_f32 v22, v22
    v_exp_f32 v23, v23
    v_exp_f32 v24, v24
    v_exp_f32 v25, v25
    v_smfmac_f32_32x32x32_bf16 v[40:55], v[100:103], v[16:23], v7
    s_waitcnt lgkmcnt(0)
    v_exp_f32 v26, v26
    v_exp_f32 v27, v27
    v_exp_f32 v28, v28
    v_mfma_f32_32x32x16_bf16 v[8:23], v[80:83], v[72:75], 0
    v_readfirstlane_b32 s75, v6
    v_exp_f32 v29, v29
    v_exp_f32 v30, v30
    v_exp_f32 v31, v31
    v_exp_f32 v32, v32
    v_exp_f32 v33, v33
    v_smfmac_f32_32x32x32_bf16 v[56:71], v[96:99], v[24:31], v7
    s_cmp_lt_u32 s75, 4
    s_setprio 0
    s_cbranch_scc1 Lpr24
    s_setprio 1
Lpr24:
    v_exp_f32 v34, v34
    v_exp_f32 v35, v35
    v_exp_f32 v36, v36
    v_exp_f32 v37, v37
    v_exp_f32 v38, v38
    v_exp_f32 v39, v39
    s_lshl_b32 s68, s5, 3
    s_add_u32 s68, s68, 161828
    s_waitcnt vmcnt(0)
    v_mov_b32 v6, s68
    s_mov_b64 exec, 1
    ds_inc_u32 v6, v7
    s_mov_b64 exec, -1
    s_cmp_eq_u32 s5, 0
    s_cbranch_scc0 L_noPS0
    s_waitcnt vmcnt(0)
    s_lshl_b32 s68, s41, 10
    s_add_u32 s68, s68, 12582912
    buffer_store_dwordx4 v[232:235], v3, s[12:15], s68 offen sc1
    s_bitcmp1_b32 s4, 0
    s_cbranch_scc1 L_nowo2
    v_lshl_or_b32 v244, v237, 16, v236
    v_lshl_or_b32 v245, v239, 16, v238
    v_lshl_or_b32 v246, v241, 16, v240
    v_lshl_or_b32 v247, v243, 16, v242
    s_lshl_b32 s68, s41, 9
    s_add_u32 s68, s68, 13631488
    buffer_store_dwordx4 v[244:247], v3, s[12:15], s68 offen sc1
L_nowo2:
L_noPS0:
    s_cmp_eq_u32 s5, 1
    s_cbranch_scc0 L_noE41
    s_waitcnt vmcnt(0)
    v_mov_b32 v240, 0
    v_mov_b32 v241, 0
    s_cmp_le_u32 s34, 0
    s_cbranch_scc1 L_hin
    v_pk_fma_f32 v[210:211], v[240:241], v[206:207], v[210:211] op_sel:[0,0,0] op_sel_hi:[1,0,1]
    v_pk_fma_f32 v[240:241], v[240:241], v[206:207], v[210:211] op_sel:[1,1,0] op_sel_hi:[0,1,1] neg_lo:[0,1,0]
    s_cmp_le_u32 s34, 1
    s_cbranch_scc1 L_hin
    v_pk_fma_f32 v[212:213], v[240:241], v[206:207], v[212:213] op_sel:[0,0,0] op_sel_hi:[1,0,1]
    v_pk_fma_f32 v[240:241], v[240:241], v[206:207], v[212:213] op_sel:[1,1,0] op_sel_hi:[0,1,1] neg_lo:[0,1,0]
    s_cmp_le_u32 s34, 2
    s_cbranch_scc1 L_hin
    v_pk_fma_f32 v[214:215], v[240:241], v[206:207], v[214:215] op_sel:[0,0,0] op_sel_hi:[1,0,1]
    v_pk_fma_f32 v[240:241], v[240:241], v[206:207], v[214:215] op_sel:[1,1,0] op_sel_hi:[0,1,1] neg_lo:[0,1,0]
    s_cmp_le_u32 s34, 3
    s_cbranch_scc1 L_hin
    v_pk_fma_f32 v[216:217], v[240:241], v[206:207], v[216:217] op_sel:[0,0,0] op_sel_hi:[1,0,1]
    v_pk_fma_f32 v[240:241], v[240:241], v[206:207], v[216:217] op_sel:[1,1,0] op_sel_hi:[0,1,1] neg_lo:[0,1,0]
    s_cmp_le_u32 s34, 4
    s_cbranch_scc1 L_hin
    v_pk_fma_f32 v[218:219], v[240:241], v[206:207], v[218:219] op_sel:[0,0,0] op_sel_hi:[1,0,1]
    v_pk_fma_f32 v[240:241], v[240:241], v[206:207], v[218:219] op_sel:[1,1,0] op_sel_hi:[0,1,1] neg_lo:[0,1,0]
    s_cmp_le_u32 s34, 5
    s_cbranch_scc1 L_hin
    v_pk_fma_f32 v[220:221], v[240:241], v[206:207], v[220:221] op_sel:[0,0,0] op_sel_hi:[1,0,1]
    v_pk_fma_f32 v[240:241], v[240:241], v[206:207], v[220:221] op_sel:[1,1,0] op_sel_hi:[0,1,1] neg_lo:[0,1,0]
    s_cmp_le_u32 s34, 6
    s_cbranch_scc1 L_hin
    v_pk_fma_f32 v[222:223], v[240:241], v[206:207], v[222:223] op_sel:[0,0,0] op_sel_hi:[1,0,1]
    v_pk_fma_f32 v[240:241], v[240:241], v[206:207], v[222:223] op_sel:[1,1,0] op_sel_hi:[0,1,1] neg_lo:[0,1,0]
    s_cmp_le_u32 s34, 7
    s_cbranch_scc1 L_hin
    v_pk_fma_f32 v[224:225], v[240:241], v[206:207], v[224:225] op_sel:[0,0,0] op_sel_hi:[1,0,1]
    v_pk_fma_f32 v[240:241], v[240:241], v[206:207], v[224:225] op_sel:[1,1,0] op_sel_hi:[0,1,1] neg_lo:[0,1,0]
    s_cmp_le_u32 s34, 8
    s_cbranch_scc1 L_hin
    v_pk_fma_f32 v[226:227], v[240:241], v[206:207], v[226:227] op_sel:[0,0,0] op_sel_hi:[1,0,1]
    v_pk_fma_f32 v[240:241], v[240:241], v[206:207], v[226:227] op_sel:[1,1,0] op_sel_hi:[0,1,1] neg_lo:[0,1,0]
    s_cmp_le_u32 s34, 9
    s_cbranch_scc1 L_hin
    v_pk_fma_f32 v[228:229], v[240:241], v[206:207], v[228:229] op_sel:[0,0,0] op_sel_hi:[1,0,1]
    v_pk_fma_f32 v[240:241], v[240:241], v[206:207], v[228:229] op_sel:[1,1,0] op_sel_hi:[0,1,1] neg_lo:[0,1,0]
    s_cmp_le_u32 s34, 10
    s_cbranch_scc1 L_hin
    v_pk_fma_f32 v[230:231], v[240:241], v[206:207], v[230:231] op_sel:[0,0,0] op_sel_hi:[1,0,1]
    v_pk_fma_f32 v[240:241], v[240:241], v[206:207], v[230:231] op_sel:[1,1,0] op_sel_hi:[0,1,1] neg_lo:[0,1,0]
    s_cmp_le_u32 s34, 11
    s_cbranch_scc1 L_hin
    v_pk_fma_f32 v[232:233], v[240:241], v[206:207], v[232:233] op_sel:[0,0,0] op_sel_hi:[1,0,1]
    v_pk_fma_f32 v[240:241], v[240:241], v[206:207], v[232:233] op_sel:[1,1,0] op_sel_hi:[0,1,1] neg_lo:[0,1,0]
    s_cmp_le_u32 s34, 12
    s_cbranch_scc1 L_hin
    v_pk_fma_f32 v[234:235], v[240:241], v[206:207], v[234:235] op_sel:[0,0,0] op_sel_hi:[1,0,1]
    v_pk_fma_f32 v[240:241], v[240:241], v[206:207], v[234:235] op_sel:[1,1,0] op_sel_hi:[0,1,1] neg_lo:[0,1,0]
    s_cmp_le_u32 s34, 13
    s_cbranch_scc1 L_hin
    v_pk_fma_f32 v[236:237], v[240:241], v[206:207], v[236:237] op_sel:[0,0,0] op_sel_hi:[1,0,1]
    v_pk_fma_f32 v[240:241], v[240:241], v[206:207], v[236:237] op_sel:[1,1,0] op_sel_hi:[0,1,1] neg_lo:[0,1,0]
    s_cmp_le_u32 s34, 14
    s_cbranch_scc1 L_hin
    v_pk_fma_f32 v[238:239], v[240:241], v[206:207], v[238:239] op_sel:[0,0,0] op_sel_hi:[1,0,1]
    v_pk_fma_f32 v[240:241], v[240:241], v[206:207], v[238:239] op_sel:[1,1,0] op_sel_hi:[0,1,1] neg_lo:[0,1,0]
L_hin:
    v_fmac_f32 v208, v204, v240
    v_fmac_f32 v209, v204, v241
    v_fma_f32 v208, -v205, v241, v208
    v_fmac_f32 v209, v205, v240
    v_fmac_f32 v168, v200, v208
    v_fmac_f32 v184, v200, v209
    v_fma_f32 v168, -v201, v209, v168
    v_fmac_f32 v184, v201, v208
    v_fmac_f32 v169, v200, v168
    v_fmac_f32 v185, v200, v184
    v_fma_f32 v169, -v201, v184, v169
    v_fmac_f32 v185, v201, v168
    v_cvt_pk_bf16_f32 v234, v168, v169
    v_cvt_pk_bf16_f32 v242, -v184, -v185
    v_fmac_f32 v170, v200, v169
    v_fmac_f32 v186, v200, v185
    v_fma_f32 v170, -v201, v185, v170
    v_fmac_f32 v186, v201, v169
    v_fmac_f32 v171, v200, v170
    v_fmac_f32 v187, v200, v186
    v_fma_f32 v171, -v201, v186, v171
    v_fmac_f32 v187, v201, v170
    v_cvt_pk_bf16_f32 v235, v170, v171
    v_cvt_pk_bf16_f32 v243, -v186, -v187
    v_fmac_f32 v172, v200, v171
    v_fmac_f32 v188, v200, v187
    v_fma_f32 v172, -v201, v187, v172
    v_fmac_f32 v188, v201, v171
    v_fmac_f32 v173, v200, v172
    v_fmac_f32 v189, v200, v188
    v_fma_f32 v173, -v201, v188, v173
    v_fmac_f32 v189, v201, v172
    v_cvt_pk_bf16_f32 v236, v172, v173
    v_cvt_pk_bf16_f32 v244, -v188, -v189
    v_fmac_f32 v174, v200, v173
    v_fmac_f32 v190, v200, v189
    v_fma_f32 v174, -v201, v189, v174
    v_fmac_f32 v190, v201, v173
    v_fmac_f32 v175, v200, v174
    v_fmac_f32 v191, v200, v190
    v_fma_f32 v175, -v201, v190, v175
    v_fmac_f32 v191, v201, v174
    v_cvt_pk_bf16_f32 v237, v174, v175
    v_cvt_pk_bf16_f32 v245, -v190, -v191
    v_fmac_f32 v176, v200, v175
    v_fmac_f32 v192, v200, v191
    v_fma_f32 v176, -v201, v191, v176
    v_fmac_f32 v192, v201, v175
    v_fmac_f32 v177, v200, v176
    v_fmac_f32 v193, v200, v192
    v_fma_f32 v177, -v201, v192, v177
    v_fmac_f32 v193, v201, v176
    v_cvt_pk_bf16_f32 v238, v176, v177
    v_cvt_pk_bf16_f32 v246, -v192, -v193
    v_fmac_f32 v178, v200, v177
    v_fmac_f32 v194, v200, v193
    v_fma_f32 v178, -v201, v193, v178
    v_fmac_f32 v194, v201, v177
    v_fmac_f32 v179, v200, v178
    v_fmac_f32 v195, v200, v194
    v_fma_f32 v179, -v201, v194, v179
    v_fmac_f32 v195, v201, v178
    v_cvt_pk_bf16_f32 v239, v178, v179
    v_cvt_pk_bf16_f32 v247, -v194, -v195
    v_fmac_f32 v180, v200, v179
    v_fmac_f32 v196, v200, v195
    v_fma_f32 v180, -v201, v195, v180
    v_fmac_f32 v196, v201, v179
    v_fmac_f32 v181, v200, v180
    v_fmac_f32 v197, v200, v196
    v_fma_f32 v181, -v201, v196, v181
    v_fmac_f32 v197, v201, v180
    v_cvt_pk_bf16_f32 v240, v180, v181
    v_cvt_pk_bf16_f32 v248, -v196, -v197
    v_fmac_f32 v182, v200, v181
    v_fmac_f32 v198, v200, v197
    v_fma_f32 v182, -v201, v197, v182
    v_fmac_f32 v198, v201, v181
    v_fmac_f32 v183, v200, v182
    v_fmac_f32 v199, v200, v198
    v_fma_f32 v183, -v201, v198, v183
    v_fmac_f32 v199, v201, v182
    v_cvt_pk_bf16_f32 v241, v182, v183
    v_cvt_pk_bf16_f32 v249, -v198, -v199
    s_lshl_b32 s68, s7, 16
    s_lshl_b32 s69, s35, 11
    s_add_u32 s68, s68, s69
    s_add_u32 s68, s68, 8388608
    s_add_u32 s69, s68, 0x8000
    ds_write_b128 v202, v[234:237] offset:0
    ds_write_b128 v202, v[238:241] offset:16
    ds_read_b64_tr_b16 v[210:211], v203 offset:0
    ds_read_b64_tr_b16 v[212:213], v203 offset:320
    ds_read_b64_tr_b16 v[214:215], v203 offset:1280
    ds_read_b64_tr_b16 v[216:217], v203 offset:1600
    ds_write_b128 v202, v[242:245] offset:0
    ds_write_b128 v202, v[246:249] offset:16
    ds_read_b64_tr_b16 v[218:219], v203 offset:0
    ds_read_b64_tr_b16 v[220:221], v203 offset:320
    ds_read_b64_tr_b16 v[222:223], v203 offset:1280
    ds_read_b64_tr_b16 v[224:225], v203 offset:1600
    s_waitcnt lgkmcnt(6)
    buffer_store_dwordx4 v[210:213], v3, s[12:15], s68 offen offset:0 sc1
    buffer_store_dwordx4 v[214:217], v3, s[12:15], s68 offen offset:1024 sc1
    s_waitcnt lgkmcnt(0)
    buffer_store_dwordx4 v[218:221], v3, s[12:15], s69 offen offset:0 sc1
    buffer_store_dwordx4 v[222:225], v3, s[12:15], s69 offen offset:1024 sc1
L_noE41:
    v_exp_f32 v8, v8
    v_exp_f32 v9, v9
    v_smfmac_f32_32x32x32_bf16 v[56:71], v[100:103], v[32:39], v7
    s_mov_b64 exec, s[44:45]
    ds_read_b128 v[96:99], v2 offset:19456
    ds_read_b128 v[100:103], v2 offset:19968
    s_mov_b64 exec, -1
    v_exp_f32 v10, v10
    v_exp_f32 v11, v11
    v_exp_f32 v12, v12
    v_mfma_f32_32x32x16_bf16 v[24:39], v[80:83], v[76:79], 0
    ds_read_b128 v[80:83], v250 offset:20480
    v_exp_f32 v13, v13
    v_exp_f32 v14, v14
    v_exp_f32 v15, v15
    v_exp_f32 v16, v16
    v_exp_f32 v17, v17
    v_smfmac_f32_32x32x32_bf16 v[40:55], v[88:91], v[8:15], v7
    v_exp_f32 v18, v18
    v_exp_f32 v19, v19
    v_exp_f32 v20, v20
    v_exp_f32 v21, v21
    v_exp_f32 v22, v22
    v_exp_f32 v23, v23
    v_exp_f32 v24, v24
    v_exp_f32 v25, v25
    v_smfmac_f32_32x32x32_bf16 v[40:55], v[92:95], v[16:23], v7
    s_waitcnt lgkmcnt(0)
    v_exp_f32 v26, v26
    v_exp_f32 v27, v27
    v_exp_f32 v28, v28
    v_mfma_f32_32x32x16_bf16 v[8:23], v[84:87], v[72:75], 0
    s_mov_b64 exec, 1
    ds_inc_u32 v1, v7
    ds_inc_u32 v1, v7 offset:8
    s_mov_b64 exec, -1
    v_exp_f32 v29, v29
    v_exp_f32 v30, v30
    v_exp_f32 v31, v31
    v_exp_f32 v32, v32
    v_exp_f32 v33, v33
    v_smfmac_f32_32x32x32_bf16 v[56:71], v[88:91], v[24:31], v7
    ds_read_b32 v6, v1 offset:4
    v_exp_f32 v34, v34
    v_exp_f32 v35, v35
    v_exp_f32 v36, v36
    v_exp_f32 v37, v37
    v_exp_f32 v38, v38
    v_exp_f32 v39, v39
    v_exp_f32 v8, v8
    v_exp_f32 v9, v9
    v_smfmac_f32_32x32x32_bf16 v[56:71], v[92:95], v[32:39], v7
    s_mov_b64 exec, s[44:45]
    ds_read_b128 v[88:91], v2 offset:21504
    ds_read_b128 v[92:95], v2 offset:22016
    s_mov_b64 exec, -1
    v_exp_f32 v10, v10
    v_exp_f32 v11, v11
    v_exp_f32 v12, v12
    v_mfma_f32_32x32x16_bf16 v[24:39], v[84:87], v[76:79], 0
    ds_read_b128 v[84:87], v250 offset:22528
    v_exp_f32 v13, v13
    v_exp_f32 v14, v14
    v_exp_f32 v15, v15
    v_exp_f32 v16, v16
    v_exp_f32 v17, v17
    v_smfmac_f32_32x32x32_bf16 v[40:55], v[96:99], v[8:15], v7
    v_exp_f32 v18, v18
    v_exp_f32 v19, v19
    v_exp_f32 v20, v20
    v_exp_f32 v21, v21
    v_exp_f32 v22, v22
    v_exp_f32 v23, v23
    v_exp_f32 v24, v24
    v_exp_f32 v25, v25
    v_smfmac_f32_32x32x32_bf16 v[40:55], v[100:103], v[16:23], v7
    s_waitcnt lgkmcnt(0)
    v_exp_f32 v26, v26
    v_exp_f32 v27, v27
    v_exp_f32 v28, v28
    v_mfma_f32_32x32x16_bf16 v[8:23], v[80:83], v[72:75], 0
    v_readfirstlane_b32 s75, v6
    v_exp_f32 v29, v29
    v_exp_f32 v30, v30
    v_exp_f32 v31, v31
    v_exp_f32 v32, v32
    v_exp_f32 v33, v33
    v_smfmac_f32_32x32x32_bf16 v[56:71], v[96:99], v[24:31], v7
    s_cmp_lt_u32 s75, 5
    s_setprio 0
    s_cbranch_scc1 Lpr25
    s_setprio 1
Lpr25:
    v_exp_f32 v34, v34
    v_exp_f32 v35, v35
    v_exp_f32 v36, v36
    v_exp_f32 v37, v37
    v_exp_f32 v38, v38
    v_exp_f32 v39, v39
    s_cmp_eq_u32 s5, 0
    s_cbranch_scc0 L_noPSb0
    s_add_u32 s40, s40, 196608
    s_waitcnt vmcnt(0)
    v_mov_b32 v4, s32
    v_mov_b32 v5, s33
    s_mov_b64 exec, 1
    buffer_store_dwordx2 v[4:5], off, s[12:15], s40 sc1
    s_mov_b64 exec, -1
L_noPSb0:
    s_cmp_eq_u32 s5, 1
    s_cbranch_scc0 L_noE4b1
    s_lshl_b32 s68, s7, 10
    s_lshl_b32 s69, s35, 6
    s_add_u32 s68, s68, s69
    s_add_u32 s68, s68, 14417920
    s_waitcnt vmcnt(0)
    v_mov_b32 v4, s32
    v_mov_b32 v5, s33
    s_mov_b64 exec, 1
    buffer_store_dwordx2 v[4:5], off, s[12:15], s68 sc1
    s_mov_b64 exec, -1
L_noE4b1:
    v_exp_f32 v8, v8
    v_exp_f32 v9, v9
    v_smfmac_f32_32x32x32_bf16 v[56:71], v[100:103], v[32:39], v7
    s_mov_b64 exec, s[44:45]
    ds_read_b128 v[96:99], v2 offset:23552
    ds_read_b128 v[100:103], v2 offset:24064
    s_mov_b64 exec, -1
    v_exp_f32 v10, v10
    v_exp_f32 v11, v11
    v_exp_f32 v12, v12
    v_mfma_f32_32x32x16_bf16 v[24:39], v[80:83], v[76:79], 0
    ds_read_b128 v[80:83], v250 offset:24576
    v_exp_f32 v13, v13
    v_exp_f32 v14, v14
    v_exp_f32 v15, v15
    v_exp_f32 v16, v16
    v_exp_f32 v17, v17
    v_smfmac_f32_32x32x32_bf16 v[40:55], v[88:91], v[8:15], v7
    v_exp_f32 v18, v18
    v_exp_f32 v19, v19
    v_exp_f32 v20, v20
    v_exp_f32 v21, v21
    v_exp_f32 v22, v22
    v_exp_f32 v23, v23
    v_exp_f32 v24, v24
    v_exp_f32 v25, v25
    v_smfmac_f32_32x32x32_bf16 v[40:55], v[92:95], v[16:23], v7
    s_waitcnt lgkmcnt(0)
    v_exp_f32 v26, v26
    v_exp_f32 v27, v27
    v_exp_f32 v28, v28
    v_mfma_f32_32x32x16_bf16 v[8:23], v[84:87], v[72:75], 0
    s_mov_b64 exec, 1
    ds_inc_u32 v1, v7
    ds_inc_u32 v1, v7 offset:8
    s_mov_b64 exec, -1
    v_exp_f32 v29, v29
    v_exp_f32 v30, v30
    v_exp_f32 v31, v31
    v_exp_f32 v32, v32
    v_exp_f32 v33, v33
    v_smfmac_f32_32x32x32_bf16 v[56:71], v[88:91], v[24:31], v7
    ds_read_b32 v6, v1 offset:4
    v_exp_f32 v34, v34
    v_exp_f32 v35, v35
    v_exp_f32 v36, v36
    v_exp_f32 v37, v37
    v_exp_f32 v38, v38
    v_exp_f32 v39, v39
    v_exp_f32 v8, v8
    v_exp_f32 v9, v9
    v_smfmac_f32_32x32x32_bf16 v[56:71], v[92:95], v[32:39], v7
    s_mov_b64 exec, s[44:45]
    ds_read_b128 v[88:91], v2 offset:25600
    ds_read_b128 v[92:95], v2 offset:26112
    s_mov_b64 exec, -1
    v_exp_f32 v10, v10
    v_exp_f32 v11, v11
    v_exp_f32 v12, v12
    v_mfma_f32_32x32x16_bf16 v[24:39], v[84:87], v[76:79], 0
    ds_read_b128 v[84:87], v250 offset:26624
    v_exp_f32 v13, v13
    v_exp_f32 v14, v14
    v_exp_f32 v15, v15
    v_exp_f32 v16, v16
    v_exp_f32 v17, v17
    v_smfmac_f32_32x32x32_bf16 v[40:55], v[96:99], v[8:15], v7
    v_exp_f32 v18, v18
    v_exp_f32 v19, v19
    v_exp_f32 v20, v20
    v_exp_f32 v21, v21
    v_exp_f32 v22, v22
    v_exp_f32 v23, v23
    v_exp_f32 v24, v24
    v_exp_f32 v25, v25
    v_smfmac_f32_32x32x32_bf16 v[40:55], v[100:103], v[16:23], v7
    s_waitcnt lgkmcnt(0)
    v_exp_f32 v26, v26
    v_exp_f32 v27, v27
    v_exp_f32 v28, v28
    v_mfma_f32_32x32x16_bf16 v[8:23], v[80:83], v[72:75], 0
    v_readfirstlane_b32 s75, v6
    v_exp_f32 v29, v29
    v_exp_f32 v30, v30
    v_exp_f32 v31, v31
    v_exp_f32 v32, v32
    v_exp_f32 v33, v33
    v_smfmac_f32_32x32x32_bf16 v[56:71], v[96:99], v[24:31], v7
    s_cmp_lt_u32 s75, 6
    s_setprio 0
    s_cbranch_scc1 Lpr26
    s_setprio 1
Lpr26:
    v_exp_f32 v34, v34
    v_exp_f32 v35, v35
    v_exp_f32 v36, v36
    v_exp_f32 v37, v37
    v_exp_f32 v38, v38
    v_exp_f32 v39, v39
    v_exp_f32 v8, v8
    v_exp_f32 v9, v9
    v_smfmac_f32_32x32x32_bf16 v[56:71], v[100:103], v[32:39], v7
    s_mov_b64 exec, s[44:45]
    ds_read_b128 v[96:99], v2 offset:27648
    ds_read_b128 v[100:103], v2 offset:28160
    s_mov_b64 exec, -1
    v_exp_f32 v10, v10
    v_exp_f32 v11, v11
    v_exp_f32 v12, v12
    v_mfma_f32_32x32x16_bf16 v[24:39], v[80:83], v[76:79], 0
    ds_read_b128 v[80:83], v250 offset:28672
    v_exp_f32 v13, v13
    v_exp_f32 v14, v14
    v_exp_f32 v15, v15
    v_exp_f32 v16, v16
    v_exp_f32 v17, v17
    v_smfmac_f32_32x32x32_bf16 v[40:55], v[88:91], v[8:15], v7
    v_exp_f32 v18, v18
    v_exp_f32 v19, v19
    v_exp_f32 v20, v20
    v_exp_f32 v21, v21
    v_exp_f32 v22, v22
    v_exp_f32 v23, v23
    v_exp_f32 v24, v24
    v_exp_f32 v25, v25
    v_smfmac_f32_32x32x32_bf16 v[40:55], v[92:95], v[16:23], v7
    s_waitcnt lgkmcnt(0)
    v_exp_f32 v26, v26
    v_exp_f32 v27, v27
    v_exp_f32 v28, v28
    v_mfma_f32_32x32x16_bf16 v[8:23], v[84:87], v[72:75], 0
    s_mov_b64 exec, 1
    ds_inc_u32 v1, v7
    ds_inc_u32 v1, v7 offset:8
    s_mov_b64 exec, -1
    v_exp_f32 v29, v29
    v_exp_f32 v30, v30
    v_exp_f32 v31, v31
    v_exp_f32 v32, v32
    v_exp_f32 v33, v33
    v_smfmac_f32_32x32x32_bf16 v[56:71], v[88:91], v[24:31], v7
    ds_read_b32 v6, v1 offset:4
    v_exp_f32 v34, v34
    v_exp_f32 v35, v35
    v_exp_f32 v36, v36
    v_exp_f32 v37, v37
    v_exp_f32 v38, v38
    v_exp_f32 v39, v39
    v_exp_f32 v8, v8
    v_exp_f32 v9, v9
    v_smfmac_f32_32x32x32_bf16 v[56:71], v[92:95], v[32:39], v7
    s_mov_b64 exec, s[44:45]
    ds_read_b128 v[88:91], v2 offset:29696
    ds_read_b128 v[92:95], v2 offset:30208
    s_mov_b64 exec, -1
    v_exp_f32 v10, v10
    v_exp_f32 v11, v11
    v_exp_f32 v12, v12
    v_mfma_f32_32x32x16_bf16 v[24:39], v[84:87], v[76:79], 0
    ds_read_b128 v[84:87], v250 offset:30720
    v_exp_f32 v13, v13
    v_exp_f32 v14, v14
    v_exp_f32 v15, v15
    v_exp_f32 v16, v16
    v_exp_f32 v17, v17
    v_smfmac_f32_32x32x32_bf16 v[40:55], v[96:99], v[8:15], v7
    v_exp_f32 v18, v18
    v_exp_f32 v19, v19
    v_exp_f32 v20, v20
    v_exp_f32 v21, v21
    v_exp_f32 v22, v22
    v_exp_f32 v23, v23
    v_exp_f32 v24, v24
    v_exp_f32 v25, v25
    v_smfmac_f32_32x32x32_bf16 v[40:55], v[100:103], v[16:23], v7
    s_waitcnt lgkmcnt(0)
    v_exp_f32 v26, v26
    v_exp_f32 v27, v27
    v_exp_f32 v28, v28
    v_mfma_f32_32x32x16_bf16 v[8:23], v[80:83], v[72:75], 0
    v_readfirstlane_b32 s75, v6
    v_exp_f32 v29, v29
    v_exp_f32 v30, v30
    v_exp_f32 v31, v31
    v_exp_f32 v32, v32
    v_exp_f32 v33, v33
    v_smfmac_f32_32x32x32_bf16 v[56:71], v[96:99], v[24:31], v7
    s_cmp_lt_u32 s75, 7
    s_setprio 0
    s_cbranch_scc1 Lpr27
    s_setprio 1
Lpr27:
    v_exp_f32 v34, v34
    v_exp_f32 v35, v35
    v_exp_f32 v36, v36
    v_exp_f32 v37, v37
    v_exp_f32 v38, v38
    v_exp_f32 v39, v39
    s_lshl_b32 s68, s5, 3
    s_add_u32 s68, s68, 161828
    v_mov_b32 v251, s68
    s_mov_b32 s81, 3200000
Lspin28:
    ds_read_b32 v6, v251
    s_sub_u32 s81, s81, 1
    s_cbranch_scc1 Lspinx28
    s_waitcnt lgkmcnt(0)
    v_cmp_ne_u32 s[78:79], 4, v6
    s_nop 0
    s_cmp_eq_u64 s[78:79], 0
    s_cbranch_scc1 Lspinx28
    s_sleep 1
    s_branch Lspin28
Lspinx28:
    s_waitcnt lgkmcnt(0)
    v_and_b32 v6, 15, v0
    v_bfe_u32 v252, v0, 4, 1
    v_lshl_add_u32 v6, v252, 6, v6
    v_lshlrev_b32 v6, 6, v6
    s_lshl_b32 s41, s39, 13
    s_lshl_b32 s68, s4, 10
    s_add_u32 s41, s41, s68
    s_add_u32 s41, s41, 14483456
    buffer_load_dwordx2 v[252:253], v6, s[12:15], s41 offen sc1
    v_exp_f32 v8, v8
    v_exp_f32 v9, v9
    v_smfmac_f32_32x32x32_bf16 v[56:71], v[100:103], v[32:39], v7
    s_mov_b64 exec, s[44:45]
    ds_read_b128 v[96:99], v2 offset:31744
    ds_read_b128 v[100:103], v2 offset:32256
    s_mov_b64 exec, -1
    v_exp_f32 v10, v10
    v_exp_f32 v11, v11
    v_exp_f32 v12, v12
    v_mfma_f32_32x32x16_bf16 v[24:39], v[80:83], v[76:79], 0
    ds_read_b128 v[80:83], v250 offset:32768
    v_exp_f32 v13, v13
    v_exp_f32 v14, v14
    v_exp_f32 v15, v15
    v_exp_f32 v16, v16
    v_exp_f32 v17, v17
    v_smfmac_f32_32x32x32_bf16 v[40:55], v[88:91], v[8:15], v7
    v_exp_f32 v18, v18
    v_exp_f32 v19, v19
    v_exp_f32 v20, v20
    v_exp_f32 v21, v21
    v_exp_f32 v22, v22
    v_exp_f32 v23, v23
    v_exp_f32 v24, v24
    v_exp_f32 v25, v25
    v_smfmac_f32_32x32x32_bf16 v[40:55], v[92:95], v[16:23], v7
    s_waitcnt lgkmcnt(0)
    v_exp_f32 v26, v26
    v_exp_f32 v27, v27
    v_exp_f32 v28, v28
    v_mfma_f32_32x32x16_bf16 v[8:23], v[84:87], v[72:75], 0
    s_mov_b64 exec, 1
    ds_inc_u32 v1, v7
    ds_inc_u32 v1, v7 offset:8
    s_mov_b64 exec, -1
    v_exp_f32 v29, v29
    v_exp_f32 v30, v30
    v_exp_f32 v31, v31
    v_exp_f32 v32, v32
    v_exp_f32 v33, v33
    v_smfmac_f32_32x32x32_bf16 v[56:71], v[88:91], v[24:31], v7
    ds_read_b32 v6, v1 offset:4
    v_exp_f32 v34, v34
    v_exp_f32 v35, v35
    v_exp_f32 v36, v36
    v_exp_f32 v37, v37
    v_exp_f32 v38, v38
    v_exp_f32 v39, v39
    v_exp_f32 v8, v8
    v_exp_f32 v9, v9
    v_smfmac_f32_32x32x32_bf16 v[56:71], v[92:95], v[32:39], v7
    s_mov_b64 exec, s[44:45]
    ds_read_b128 v[88:91], v2 offset:33792
    ds_read_b128 v[92:95], v2 offset:34304
    s_mov_b64 exec, -1
    v_exp_f32 v10, v10
    v_exp_f32 v11, v11
    v_exp_f32 v12, v12
    v_mfma_f32_32x32x16_bf16 v[24:39], v[84:87], v[76:79], 0
    ds_read_b128 v[84:87], v250 offset:34816
    v_exp_f32 v13, v13
    v_exp_f32 v14, v14
    v_exp_f32 v15, v15
    v_exp_f32 v16, v16
    v_exp_f32 v17, v17
    v_smfmac_f32_32x32x32_bf16 v[40:55], v[96:99], v[8:15], v7
    v_exp_f32 v18, v18
    v_exp_f32 v19, v19
    v_exp_f32 v20, v20
    v_exp_f32 v21, v21
    v_exp_f32 v22, v22
    v_exp_f32 v23, v23
    v_exp_f32 v24, v24
    v_exp_f32 v25, v25
    v_smfmac_f32_32x32x32_bf16 v[40:55], v[100:103], v[16:23], v7
    s_waitcnt lgkmcnt(0)
    v_exp_f32 v26, v26
    v_exp_f32 v27, v27
    v_exp_f32 v28, v28
    v_mfma_f32_32x32x16_bf16 v[8:23], v[80:83], v[72:75], 0
    v_readfirstlane_b32 s75, v6
    v_exp_f32 v29, v29
    v_exp_f32 v30, v30
    v_exp_f32 v31, v31
    v_exp_f32 v32, v32
    v_exp_f32 v33, v33
    v_smfmac_f32_32x32x32_bf16 v[56:71], v[96:99], v[24:31], v7
    s_cmp_lt_u32 s75, 8
    s_setprio 0
    s_cbranch_scc1 Lpr29
    s_setprio 1
Lpr29:
    v_exp_f32 v34, v34
    v_exp_f32 v35, v35
    v_exp_f32 v36, v36
    v_exp_f32 v37, v37
    v_exp_f32 v38, v38
    v_exp_f32 v39, v39
    s_waitcnt vmcnt(0)
    v_cmp_eq_u32 s[78:79], s32, v252
    v_cmp_eq_u32 vcc, s33, v253
    s_nop 0
    s_and_b64 s[78:79], s[78:79], vcc
    s_cmp_eq_u64 s[78:79], -1
    s_cbranch_scc1 Lchk30
    v_and_b32 v6, 15, v0
    v_bfe_u32 v252, v0, 4, 1
    v_lshl_add_u32 v6, v252, 6, v6
    v_lshlrev_b32 v6, 6, v6
    s_lshl_b32 s41, s39, 13
    s_lshl_b32 s68, s4, 10
    s_add_u32 s41, s41, s68
    s_add_u32 s41, s41, 14483456
    buffer_load_dwordx2 v[252:253], v6, s[12:15], s41 offen sc1
    s_mov_b32 s81, 400000
Lpoll31:
    buffer_load_dwordx2 v[252:253], v6, s[12:15], s41 offen sc1
    s_sub_u32 s81, s81, 1
    s_cbranch_scc1 Lpollx31
    s_waitcnt vmcnt(0)
    v_cmp_eq_u32 s[78:79], s32, v252
    v_cmp_eq_u32 vcc, s33, v253
    s_nop 0
    s_and_b64 s[78:79], s[78:79], vcc
    s_cmp_eq_u64 s[78:79], -1
    s_cbranch_scc1 Lpollx31
    s_sleep 2
    s_branch Lpoll31
Lpollx31:
    s_waitcnt vmcnt(0)
Lchk30:
    s_lshl_b32 s62, s39, 16
    s_lshl_b32 s69, s4, 13
    s_add_u32 s62, s62, s69
    s_add_u32 s62, s62, 13631488
    s_cmp_eq_u32 s5, 0
    s_cbranch_scc0 L_noE5a0
    v_and_b32 v4, 7, v0
    v_and_b32 v5, 4, v4
    v_and_b32 v4, 3, v4
    v_lshl_add_u32 v4, v5, 1, v4
    v_and_b32 v5, 3, v0
    v_add_u32 v4, v4, v5
    s_lshr_b32 s68, s49, 5
    v_add_u32 v4, s68, v4
    s_lshl_b32 s68, s4, 4
    s_bfe_u32 s69, s49, 0x20003
    s_lshl_b32 s69, s69, 2
    s_add_u32 s68, s68, s69
    s_bfe_u32 s69, s49, 0x20001
    s_add_u32 s68, s68, s69
    v_lshl_add_u32 v4, v4, 6, s68
    s_lshl_b32 s68, s49, 4
    s_add_u32 s68, s68, 2048
    v_cmp_gt_u32 vcc, 16, v0
    v_add_u32 v5, s68, v0
    s_mov_b32 s48, 14286848
    v_cndmask_b32 v6, v4, v5, vcc
    v_bfe_u32 v5, v0, 2, 2
    v_mul_u32_u24 v5, 5, v5
    v_and_b32 v5, 9, v5
    s_and_b32 s68, s46, 3
    s_lshl_b32 s68, s68, 1
    v_add_u32 v5, s68, v5
    v_and_b32 v4, 3, v0
    s_and_b32 s68, s46, 0x3c
    v_add_u32 v4, s68, v4
    v_cmp_lt_u32 vcc, 31, v0
    v_lshl_add_u32 v4, v5, 6, v4
    s_nop 0
    v_cndmask_b32 v6, v6, v4, vcc
    v_lshlrev_b32 v6, 6, v6
    buffer_load_dwordx2 v[4:5], v6, s[12:15], s48 offen sc1
L_noE5a0:
    v_exp_f32 v8, v8
    v_exp_f32 v9, v9
    v_smfmac_f32_32x32x32_bf16 v[56:71], v[100:103], v[32:39], v7
    s_mov_b64 exec, s[44:45]
    ds_read_b128 v[96:99], v2 offset:35840
    ds_read_b128 v[100:103], v2 offset:36352
    s_mov_b64 exec, -1
    v_exp_f32 v10, v10
    v_exp_f32 v11, v11
    v_exp_f32 v12, v12
    v_mfma_f32_32x32x16_bf16 v[24:39], v[80:83], v[76:79], 0
    ds_read_b128 v[80:83], v250 offset:36864
    v_exp_f32 v13, v13
    v_exp_f32 v14, v14
    v_exp_f32 v15, v15
    v_exp_f32 v16, v16
    v_exp_f32 v17, v17
    v_smfmac_f32_32x32x32_bf16 v[40:55], v[88:91], v[8:15], v7
    buffer_load_dwordx4 v[104:107], v3, s[12:15], s62 offen offset:0 sc1
    buffer_load_dwordx4 v[112:115], v3, s[12:15], s62 offen offset:1024 sc1
    v_exp_f32 v18, v18
    v_exp_f32 v19, v19
    v_exp_f32 v20, v20
    v_exp_f32 v21, v21
    v_exp_f32 v22, v22
    v_exp_f32 v23, v23
    v_exp_f32 v24, v24
    v_exp_f32 v25, v25
    v_smfmac_f32_32x32x32_bf16 v[40:55], v[92:95], v[16:23], v7
    s_waitcnt lgkmcnt(0)
    v_exp_f32 v26, v26
    v_exp_f32 v27, v27
    v_exp_f32 v28, v28
    v_mfma_f32_32x32x16_bf16 v[8:23], v[84:87], v[72:75], 0
    s_mov_b64 exec, 1
    ds_inc_u32 v1, v7
    ds_inc_u32 v1, v7 offset:8
    s_mov_b64 exec, -1
    v_exp_f32 v29, v29
    v_exp_f32 v30, v30
    v_exp_f32 v31, v31
    v_exp_f32 v32, v32
    v_exp_f32 v33, v33
    v_smfmac_f32_32x32x32_bf16 v[56:71], v[88:91], v[24:31], v7
    buffer_load_dwordx4 v[120:123], v3, s[12:15], s62 offen offset:2048 sc1
    buffer_load_dwordx4 v[128:131], v3, s[12:15], s62 offen offset:3072 sc1
    s_add_u32 s62, s62, 4096
    ds_read_b32 v6, v1 offset:4
    v_exp_f32 v34, v34
    v_exp_f32 v35, v35
    v_exp_f32 v36, v36
    v_exp_f32 v37, v37
    v_exp_f32 v38, v38
    v_exp_f32 v39, v39
    v_exp_f32 v8, v8
    v_exp_f32 v9, v9
    v_smfmac_f32_32x32x32_bf16 v[56:71], v[92:95], v[32:39], v7
    s_mov_b64 exec, s[44:45]
    ds_read_b128 v[88:91], v2 offset:37888
    ds_read_b128 v[92:95], v2 offset:38400
    s_mov_b64 exec, -1
    v_exp_f32 v10, v10
    v_exp_f32 v11, v11
    v_exp_f32 v12, v12
    v_mfma_f32_32x32x16_bf16 v[24:39], v[84:87], v[76:79], 0
    ds_read_b128 v[84:87], v250 offset:38912
    v_exp_f32 v13, v13
    v_exp_f32 v14, v14
    v_exp_f32 v15, v15
    v_exp_f32 v16, v16
    v_exp_f32 v17, v17
    v_smfmac_f32_32x32x32_bf16 v[40:55], v[96:99], v[8:15], v7
    buffer_load_dwordx4 v[136:139], v3, s[12:15], s62 offen offset:0 sc1
    buffer_load_dwordx4 v[144:147], v3, s[12:15], s62 offen offset:1024 sc1
    v_exp_f32 v18, v18
    v_exp_f32 v19, v19
    v_exp_f32 v20, v20
    v_exp_f32 v21, v21
    v_exp_f32 v22, v22
    v_exp_f32 v23, v23
    v_exp_f32 v24, v24
    v_exp_f32 v25, v25
    v_smfmac_f32_32x32x32_bf16 v[40:55], v[100:103], v[16:23], v7
    s_waitcnt lgkmcnt(0)
    v_exp_f32 v26, v26
    v_exp_f32 v27, v27
    v_exp_f32 v28, v28
    v_mfma_f32_32x32x16_bf16 v[8:23], v[80:83], v[72:75], 0
    v_readfirstlane_b32 s75, v6
    v_exp_f32 v29, v29
    v_exp_f32 v30, v30
    v_exp_f32 v31, v31
    v_exp_f32 v32, v32
    v_exp_f32 v33, v33
    v_smfmac_f32_32x32x32_bf16 v[56:71], v[96:99], v[24:31], v7
    buffer_load_dwordx4 v[152:155], v3, s[12:15], s62 offen offset:2048 sc1
    buffer_load_dwordx4 v[160:163], v3, s[12:15], s62 offen offset:3072 sc1
    s_add_u32 s62, s62, 28672
    s_cmp_lt_u32 s75, 9
    s_setprio 0
    s_cbranch_scc1 Lpr32
    s_setprio 1
Lpr32:
    v_exp_f32 v34, v34
    v_exp_f32 v35, v35
    v_exp_f32 v36, v36
    v_exp_f32 v37, v37
    v_exp_f32 v38, v38
    v_exp_f32 v39, v39
    s_cmp_eq_u32 s5, 0
    s_cbranch_scc0 L_noE5b0
    s_waitcnt vmcnt(0)
    v_cmp_eq_u32 s[78:79], s32, v4
    v_cmp_eq_u32 vcc, s33, v5
    s_nop 0
    s_and_b64 s[78:79], s[78:79], vcc
    s_cmp_eq_u64 s[78:79], -1
    s_cbranch_scc1 Lchk33
    v_and_b32 v4, 7, v0
    v_and_b32 v5, 4, v4
    v_and_b32 v4, 3, v4
    v_lshl_add_u32 v4, v5, 1, v4
    v_and_b32 v5, 3, v0
    v_add_u32 v4, v4, v5
    s_lshr_b32 s68, s49, 5
    v_add_u32 v4, s68, v4
    s_lshl_b32 s68, s4, 4
    s_bfe_u32 s69, s49, 0x20003
    s_lshl_b32 s69, s69, 2
    s_add_u32 s68, s68, s69
    s_bfe_u32 s69, s49, 0x20001
    s_add_u32 s68, s68, s69
    v_lshl_add_u32 v4, v4, 6, s68
    s_lshl_b32 s68, s49, 4
    s_add_u32 s68, s68, 2048
    v_cmp_gt_u32 vcc, 16, v0
    v_add_u32 v5, s68, v0
    s_mov_b32 s48, 14286848
    v_cndmask_b32 v6, v4, v5, vcc
    v_bfe_u32 v5, v0, 2, 2
    v_mul_u32_u24 v5, 5, v5
    v_and_b32 v5, 9, v5
    s_and_b32 s68, s46, 3
    s_lshl_b32 s68, s68, 1
    v_add_u32 v5, s68, v5
    v_and_b32 v4, 3, v0
    s_and_b32 s68, s46, 0x3c
    v_add_u32 v4, s68, v4
    v_cmp_lt_u32 vcc, 31, v0
    v_lshl_add_u32 v4, v5, 6, v4
    s_nop 0
    v_cndmask_b32 v6, v6, v4, vcc
    v_lshlrev_b32 v6, 6, v6
    buffer_load_dwordx2 v[4:5], v6, s[12:15], s48 offen sc1
    s_mov_b32 s81, 400000
Lpoll34:
    buffer_load_dwordx2 v[4:5], v6, s[12:15], s48 offen sc1
    s_sub_u32 s81, s81, 1
    s_cbranch_scc1 Lpollx34
    s_waitcnt vmcnt(0)
    v_cmp_eq_u32 s[78:79], s32, v4
    v_cmp_eq_u32 vcc, s33, v5
    s_nop 0
    s_and_b64 s[78:79], s[78:79], vcc
    s_cmp_eq_u64 s[78:79], -1
    s_cbranch_scc1 Lpollx34
    s_sleep 2
    s_branch Lpoll34
Lpollx34:
    s_waitcnt vmcnt(0)
Lchk33:
    s_lshl_b32 s69, s4, 14
    s_lshl_b32 s47, s49, 16
    s_add_u32 s47, s47, s69
    s_add_u32 s47, s47, 8388608
    s_lshl_b32 s64, s39, 17
    s_add_u32 s64, s64, s69
    s_add_u32 s64, s64, 12582912
    s_add_u32 s65, s64, 0x10000
    s_and_b32 s68, s4, 1
    s_lshl_b32 s68, s68, 3
    s_lshl_b32 s40, s49, 5
    s_add_u32 s40, s40, s68
    s_lshr_b32 s68, s4, 1
    s_lshl_b32 s68, s68, 5
    s_lshl_b32 s41, s39, 6
    s_add_u32 s41, s41, s68
    v_lshrrev_b32 v4, 5, v0
    v_and_b32 v5, 31, v0
    s_lshl_b32 s68, s49, 9
    s_add_u32 s68, s68, 14155776
    v_lshlrev_b32 v6, 8, v4
    buffer_load_dwordx4 v[224:227], v6, s[12:15], s68 offen offset:0 sc1
    buffer_load_dwordx4 v[228:231], v6, s[12:15], s68 offen offset:16 sc1
    buffer_load_dwordx4 v[232:235], v6, s[12:15], s68 offen offset:128 sc1
    buffer_load_dwordx4 v[236:239], v6, s[12:15], s68 offen offset:144 sc1
    s_mov_b32 s24, s56
    s_mov_b32 s25, s57
    s_mov_b32 s26, 0x400
    s_mov_b32 s27, 0x00020000
    v_lshlrev_b32 v6, 1, v5
    s_lshl_b32 s68, s41, 1
    buffer_load_ushort v248, v6, s[24:27], s68 offen
    v_lshl_add_u32 v6, v4, 14, v6
    s_lshl_b32 s69, s40, 10
    s_add_u32 s68, s68, s69
    buffer_load_ushort v240, v6, s[8:11], s68 offen offset:0
    buffer_load_ushort v241, v6, s[8:11], s68 offen offset:1024
    buffer_load_ushort v242, v6, s[8:11], s68 offen offset:2048
    buffer_load_ushort v243, v6, s[8:11], s68 offen offset:3072
    s_add_u32 s68, s68, 4096
    buffer_load_ushort v244, v6, s[8:11], s68 offen offset:0
    buffer_load_ushort v245, v6, s[8:11], s68 offen offset:1024
    buffer_load_ushort v246, v6, s[8:11], s68 offen offset:2048
    buffer_load_ushort v247, v6, s[8:11], s68 offen offset:3072
    v_bfe_u32 v4, v5, 2, 1
    v_lshlrev_b32 v4, 4, v4
    v_and_or_b32 v4, v5, 3, v4
    v_lshrrev_b32 v5, 3, v5
    v_lshl_add_u32 v4, v5, 2, v4
    v_lshrrev_b32 v5, 3, v4
    v_and_b32 v4, 7, v4
    v_lshlrev_b32 v4, 2, v4
    v_lshl_add_u32 v4, v5, 7, v4
    s_lshl_b32 s68, s46, 9
    s_add_u32 s68, s68, 14155776
    buffer_load_dword v249, v4, s[12:15], s68 offen sc1
    buffer_load_dwordx4 v[200:203], v3, s[12:15], s47 offen offset:0 sc1
    buffer_load_dwordx4 v[204:207], v3, s[12:15], s64 offen offset:0 sc1
    buffer_load_dwordx4 v[208:211], v3, s[12:15], s65 offen offset:0 sc1
    buffer_load_dwordx4 v[212:215], v3, s[12:15], s47 offen offset:1024 sc1
    buffer_load_dwordx4 v[216:219], v3, s[12:15], s64 offen offset:1024 sc1
    buffer_load_dwordx4 v[220:223], v3, s[12:15], s65 offen offset:1024 sc1
L_noE5b0:
    s_cmp_eq_u32 s5, 1
    s_cbranch_scc0 L_noE5a1
    v_and_b32 v4, 7, v0
    v_and_b32 v5, 4, v4
    v_and_b32 v4, 3, v4
    v_lshl_add_u32 v4, v5, 1, v4
    v_and_b32 v5, 3, v0
    v_add_u32 v4, v4, v5
    s_lshr_b32 s68, s49, 5
    v_add_u32 v4, s68, v4
    s_lshl_b32 s68, s4, 4
    s_bfe_u32 s69, s49, 0x20003
    s_lshl_b32 s69, s69, 2
    s_add_u32 s68, s68, s69
    s_bfe_u32 s69, s49, 0x20001
    s_add_u32 s68, s68, s69
    v_lshl_add_u32 v4, v4, 6, s68
    s_lshl_b32 s68, s49, 4
    s_add_u32 s68, s68, 2048
    v_cmp_gt_u32 vcc, 16, v0
    v_add_u32 v5, s68, v0
    s_mov_b32 s48, 14286848
    v_cndmask_b32 v6, v4, v5, vcc
    v_bfe_u32 v5, v0, 2, 2
    v_mul_u32_u24 v5, 5, v5
    v_and_b32 v5, 9, v5
    s_and_b32 s68, s46, 3
    s_lshl_b32 s68, s68, 1
    v_add_u32 v5, s68, v5
    v_and_b32 v4, 3, v0
    s_and_b32 s68, s46, 0x3c
    v_add_u32 v4, s68, v4
    v_cmp_lt_u32 vcc, 31, v0
    v_lshl_add_u32 v4, v5, 6, v4
    s_nop 0
    v_cndmask_b32 v6, v6, v4, vcc
    v_lshlrev_b32 v6, 6, v6
    buffer_load_dwordx2 v[4:5], v6, s[12:15], s48 offen sc1
L_noE5a1:
    v_exp_f32 v8, v8
    v_exp_f32 v9, v9
    v_smfmac_f32_32x32x32_bf16 v[56:71], v[100:103], v[32:39], v7
    s_mov_b64 exec, s[44:45]
    ds_read_b128 v[96:99], v2 offset:39936
    ds_read_b128 v[100:103], v2 offset:40448
    s_mov_b64 exec, -1
    v_exp_f32 v10, v10
    v_exp_f32 v11, v11
    v_exp_f32 v12, v12
    v_mfma_f32_32x32x16_bf16 v[24:39], v[80:83], v[76:79], 0
    ds_read_b128 v[80:83], v250 offset:40960
    v_exp_f32 v13, v13
    v_exp_f32 v14, v14
    v_exp_f32 v15, v15
    v_exp_f32 v16, v16
    v_exp_f32 v17, v17
    v_smfmac_f32_32x32x32_bf16 v[40:55], v[88:91], v[8:15], v7
    buffer_load_dwordx4 v[108:111], v3, s[12:15], s62 offen offset:0 sc1
    buffer_load_dwordx4 v[116:119], v3, s[12:15], s62 offen offset:1024 sc1
    v_exp_f32 v18, v18
    v_exp_f32 v19, v19
    v_exp_f32 v20, v20
    v_exp_f32 v21, v21
    v_exp_f32 v22, v22
    v_exp_f32 v23, v23
    v_exp_f32 v24, v24
    v_exp_f32 v25, v25
    v_smfmac_f32_32x32x32_bf16 v[40:55], v[92:95], v[16:23], v7
    s_waitcnt lgkmcnt(0)
    v_exp_f32 v26, v26
    v_exp_f32 v27, v27
    v_exp_f32 v28, v28
    v_mfma_f32_32x32x16_bf16 v[8:23], v[84:87], v[72:75], 0
    s_mov_b64 exec, 1
    ds_inc_u32 v1, v7
    ds_inc_u32 v1, v7 offset:8
    s_mov_b64 exec, -1
    v_exp_f32 v29, v29
    v_exp_f32 v30, v30
    v_exp_f32 v31, v31
    v_exp_f32 v32, v32
    v_exp_f32 v33, v33
    v_smfmac_f32_32x32x32_bf16 v[56:71], v[88:91], v[24:31], v7
    buffer_load_dwordx4 v[124:127], v3, s[12:15], s62 offen offset:2048 sc1
    buffer_load_dwordx4 v[132:135], v3, s[12:15], s62 offen offset:3072 sc1
    s_add_u32 s62, s62, 4096
    ds_read_b32 v6, v1 offset:4
    v_exp_f32 v34, v34
    v_exp_f32 v35, v35
    v_exp_f32 v36, v36
    v_exp_f32 v37, v37
    v_exp_f32 v38, v38
    v_exp_f32 v39, v39
    v_exp_f32 v8, v8
    v_exp_f32 v9, v9
    v_smfmac_f32_32x32x32_bf16 v[56:71], v[92:95], v[32:39], v7
    s_mov_b64 exec, s[44:45]
    ds_read_b128 v[88:91], v2 offset:41984
    ds_read_b128 v[92:95], v2 offset:42496
    s_mov_b64 exec, -1
    v_exp_f32 v10, v10
    v_exp_f32 v11, v11
    v_exp_f32 v12, v12
    v_mfma_f32_32x32x16_bf16 v[24:39], v[84:87], v[76:79], 0
    ds_read_b128 v[84:87], v250 offset:43008
    v_exp_f32 v13, v13
    v_exp_f32 v14, v14
    v_exp_f32 v15, v15
    v_exp_f32 v16, v16
    v_exp_f32 v17, v17
    v_smfmac_f32_32x32x32_bf16 v[40:55], v[96:99], v[8:15], v7
    buffer_load_dwordx4 v[140:143], v3, s[12:15], s62 offen offset:0 sc1
    buffer_load_dwordx4 v[148:151], v3, s[12:15], s62 offen offset:1024 sc1
    v_exp_f32 v18, v18
    v_exp_f32 v19, v19
    v_exp_f32 v20, v20
    v_exp_f32 v21, v21
    v_exp_f32 v22, v22
    v_exp_f32 v23, v23
    v_exp_f32 v24, v24
    v_exp_f32 v25, v25
    v_smfmac_f32_32x32x32_bf16 v[40:55], v[100:103], v[16:23], v7
    s_waitcnt lgkmcnt(0)
    v_exp_f32 v26, v26
    v_exp_f32 v27, v27
    v_exp_f32 v28, v28
    v_mfma_f32_32x32x16_bf16 v[8:23], v[80:83], v[72:75], 0
    v_readfirstlane_b32 s75, v6
    v_exp_f32 v29, v29
    v_exp_f32 v30, v30
    v_exp_f32 v31, v31
    v_exp_f32 v32, v32
    v_exp_f32 v33, v33
    v_smfmac_f32_32x32x32_bf16 v[56:71], v[96:99], v[24:31], v7
    buffer_load_dwordx4 v[156:159], v3, s[12:15], s62 offen offset:2048 sc1
    buffer_load_dwordx4 v[164:167], v3, s[12:15], s62 offen offset:3072 sc1
    s_add_u32 s62, s62, 4096
    s_cmp_lt_u32 s75, 10
    s_setprio 0
    s_cbranch_scc1 Lpr35
    s_setprio 1
Lpr35:
    v_exp_f32 v34, v34
    v_exp_f32 v35, v35
    v_exp_f32 v36, v36
    v_exp_f32 v37, v37
    v_exp_f32 v38, v38
    v_exp_f32 v39, v39
    s_cmp_eq_u32 s5, 1
    s_cbranch_scc0 L_noE5b1
    s_waitcnt vmcnt(0)
    v_cmp_eq_u32 s[78:79], s32, v4
    v_cmp_eq_u32 vcc, s33, v5
    s_nop 0
    s_and_b64 s[78:79], s[78:79], vcc
    s_cmp_eq_u64 s[78:79], -1
    s_cbranch_scc1 Lchk36
    v_and_b32 v4, 7, v0
    v_and_b32 v5, 4, v4
    v_and_b32 v4, 3, v4
    v_lshl_add_u32 v4, v5, 1, v4
    v_and_b32 v5, 3, v0
    v_add_u32 v4, v4, v5
    s_lshr_b32 s68, s49, 5
    v_add_u32 v4, s68, v4
    s_lshl_b32 s68, s4, 4
    s_bfe_u32 s69, s49, 0x20003
    s_lshl_b32 s69, s69, 2
    s_add_u32 s68, s68, s69
    s_bfe_u32 s69, s49, 0x20001
    s_add_u32 s68, s68, s69
    v_lshl_add_u32 v4, v4, 6, s68
    s_lshl_b32 s68, s49, 4
    s_add_u32 s68, s68, 2048
    v_cmp_gt_u32 vcc, 16, v0
    v_add_u32 v5, s68, v0
    s_mov_b32 s48, 14286848
    v_cndmask_b32 v6, v4, v5, vcc
    v_bfe_u32 v5, v0, 2, 2
    v_mul_u32_u24 v5, 5, v5
    v_and_b32 v5, 9, v5
    s_and_b32 s68, s46, 3
    s_lshl_b32 s68, s68, 1
    v_add_u32 v5, s68, v5
    v_and_b32 v4, 3, v0
    s_and_b32 s68, s46, 0x3c
    v_add_u32 v4, s68, v4
    v_cmp_lt_u32 vcc, 31, v0
    v_lshl_add_u32 v4, v5, 6, v4
    s_nop 0
    v_cndmask_b32 v6, v6, v4, vcc
    v_lshlrev_b32 v6, 6, v6
    buffer_load_dwordx2 v[4:5], v6, s[12:15], s48 offen sc1
    s_mov_b32 s81, 400000
Lpoll37:
    buffer_load_dwordx2 v[4:5], v6, s[12:15], s48 offen sc1
    s_sub_u32 s81, s81, 1
    s_cbranch_scc1 Lpollx37
    s_waitcnt vmcnt(0)
    v_cmp_eq_u32 s[78:79], s32, v4
    v_cmp_eq_u32 vcc, s33, v5
    s_nop 0
    s_and_b64 s[78:79], s[78:79], vcc
    s_cmp_eq_u64 s[78:79], -1
    s_cbranch_scc1 Lpollx37
    s_sleep 2
    s_branch Lpoll37
Lpollx37:
    s_waitcnt vmcnt(0)
Lchk36:
    s_lshl_b32 s69, s4, 14
    s_lshl_b32 s47, s49, 16
    s_add_u32 s47, s47, s69
    s_add_u32 s47, s47, 8388608
    s_lshl_b32 s64, s39, 17
    s_add_u32 s64, s64, s69
    s_add_u32 s64, s64, 12582912
    s_add_u32 s65, s64, 0x10000
    s_and_b32 s68, s4, 1
    s_lshl_b32 s68, s68, 3
    s_lshl_b32 s40, s49, 5
    s_add_u32 s40, s40, s68
    s_lshr_b32 s68, s4, 1
    s_lshl_b32 s68, s68, 5
    s_lshl_b32 s41, s39, 6
    s_add_u32 s41, s41, s68
    v_lshrrev_b32 v4, 5, v0
    v_and_b32 v5, 31, v0
    s_lshl_b32 s68, s49, 9
    s_add_u32 s68, s68, 14155776
    v_lshlrev_b32 v6, 8, v4
    buffer_load_dwordx4 v[224:227], v6, s[12:15], s68 offen offset:0 sc1
    buffer_load_dwordx4 v[228:231], v6, s[12:15], s68 offen offset:16 sc1
    buffer_load_dwordx4 v[232:235], v6, s[12:15], s68 offen offset:128 sc1
    buffer_load_dwordx4 v[236:239], v6, s[12:15], s68 offen offset:144 sc1
    s_mov_b32 s24, s56
    s_mov_b32 s25, s57
    s_mov_b32 s26, 0x400
    s_mov_b32 s27, 0x00020000
    v_lshlrev_b32 v6, 1, v5
    s_lshl_b32 s68, s41, 1
    buffer_load_ushort v248, v6, s[24:27], s68 offen
    v_lshl_add_u32 v6, v4, 14, v6
    s_lshl_b32 s69, s40, 10
    s_add_u32 s68, s68, s69
    buffer_load_ushort v240, v6, s[8:11], s68 offen offset:0
    buffer_load_ushort v241, v6, s[8:11], s68 offen offset:1024
    buffer_load_ushort v242, v6, s[8:11], s68 offen offset:2048
    buffer_load_ushort v243, v6, s[8:11], s68 offen offset:3072
    s_add_u32 s68, s68, 4096
    buffer_load_ushort v244, v6, s[8:11], s68 offen offset:0
    buffer_load_ushort v245, v6, s[8:11], s68 offen offset:1024
    buffer_load_ushort v246, v6, s[8:11], s68 offen offset:2048
    buffer_load_ushort v247, v6, s[8:11], s68 offen offset:3072
    v_bfe_u32 v4, v5, 2, 1
    v_lshlrev_b32 v4, 4, v4
    v_and_or_b32 v4, v5, 3, v4
    v_lshrrev_b32 v5, 3, v5
    v_lshl_add_u32 v4, v5, 2, v4
    v_lshrrev_b32 v5, 3, v4
    v_and_b32 v4, 7, v4
    v_lshlrev_b32 v4, 2, v4
    v_lshl_add_u32 v4, v5, 7, v4
    s_lshl_b32 s68, s46, 9
    s_add_u32 s68, s68, 14155776
    buffer_load_dword v249, v4, s[12:15], s68 offen sc1
    buffer_load_dwordx4 v[200:203], v3, s[12:15], s47 offen offset:0 sc1
    buffer_load_dwordx4 v[204:207], v3, s[12:15], s64 offen offset:0 sc1
    buffer_load_dwordx4 v[208:211], v3, s[12:15], s65 offen offset:0 sc1
    buffer_load_dwordx4 v[212:215], v3, s[12:15], s47 offen offset:1024 sc1
    buffer_load_dwordx4 v[216:219], v3, s[12:15], s64 offen offset:1024 sc1
    buffer_load_dwordx4 v[220:223], v3, s[12:15], s65 offen offset:1024 sc1
L_noE5b1:
    v_exp_f32 v8, v8
    v_exp_f32 v9, v9
    v_smfmac_f32_32x32x32_bf16 v[56:71], v[100:103], v[32:39], v7
    s_mov_b64 exec, s[44:45]
    ds_read_b128 v[96:99], v2 offset:44032
    ds_read_b128 v[100:103], v2 offset:44544
    s_mov_b64 exec, -1
    v_exp_f32 v10, v10
    v_exp_f32 v11, v11
    v_exp_f32 v12, v12
    v_mfma_f32_32x32x16_bf16 v[24:39], v[80:83], v[76:79], 0
    ds_read_b128 v[80:83], v250 offset:45056
    v_exp_f32 v13, v13
    v_exp_f32 v14, v14
    v_exp_f32 v15, v15
    v_exp_f32 v16, v16
    v_exp_f32 v17, v17
    v_smfmac_f32_32x32x32_bf16 v[40:55], v[88:91], v[8:15], v7
    v_exp_f32 v18, v18
    v_exp_f32 v19, v19
    v_exp_f32 v20, v20
    v_exp_f32 v21, v21
    v_exp_f32 v22, v22
    v_exp_f32 v23, v23
    v_exp_f32 v24, v24
    v_exp_f32 v25, v25
    v_smfmac_f32_32x32x32_bf16 v[40:55], v[92:95], v[16:23], v7
    s_waitcnt lgkmcnt(0)
    v_exp_f32 v26, v26
    v_exp_f32 v27, v27
    v_exp_f32 v28, v28
    v_mfma_f32_32x32x16_bf16 v[8:23], v[84:87], v[72:75], 0
    s_mov_b64 exec, 1
    ds_inc_u32 v1, v7
    ds_inc_u32 v1, v7 offset:8
    s_mov_b64 exec, -1
    v_exp_f32 v29, v29
    v_exp_f32 v30, v30
    v_exp_f32 v31, v31
    v_exp_f32 v32, v32
    v_exp_f32 v33, v33
    v_smfmac_f32_32x32x32_bf16 v[56:71], v[88:91], v[24:31], v7
    ds_read_b32 v6, v1 offset:4
    v_exp_f32 v34, v34
    v_exp_f32 v35, v35
    v_exp_f32 v36, v36
    v_exp_f32 v37, v37
    v_exp_f32 v38, v38
    v_exp_f32 v39, v39
    v_exp_f32 v8, v8
    v_exp_f32 v9, v9
    v_smfmac_f32_32x32x32_bf16 v[56:71], v[92:95], v[32:39], v7
    s_mov_b64 exec, s[44:45]
    ds_read_b128 v[88:91], v2 offset:46080
    ds_read_b128 v[92:95], v2 offset:46592
    s_mov_b64 exec, -1
    v_exp_f32 v10, v10
    v_exp_f32 v11, v11
    v_exp_f32 v12, v12
    v_mfma_f32_32x32x16_bf16 v[24:39], v[84:87], v[76:79], 0
    ds_read_b128 v[84:87], v250 offset:47104
    v_exp_f32 v13, v13
    v_exp_f32 v14, v14
    v_exp_f32 v15, v15
    v_exp_f32 v16, v16
    v_exp_f32 v17, v17
    v_smfmac_f32_32x32x32_bf16 v[40:55], v[96:99], v[8:15], v7
    v_exp_f32 v18, v18
    v_exp_f32 v19, v19
    v_exp_f32 v20, v20
    v_exp_f32 v21, v21
    v_exp_f32 v22, v22
    v_exp_f32 v23, v23
    v_exp_f32 v24, v24
    v_exp_f32 v25, v25
    v_smfmac_f32_32x32x32_bf16 v[40:55], v[100:103], v[16:23], v7
    s_waitcnt lgkmcnt(0)
    v_exp_f32 v26, v26
    v_exp_f32 v27, v27
    v_exp_f32 v28, v28
    v_mfma_f32_32x32x16_bf16 v[8:23], v[80:83], v[72:75], 0
    v_readfirstlane_b32 s75, v6
    v_exp_f32 v29, v29
    v_exp_f32 v30, v30
    v_exp_f32 v31, v31
    v_exp_f32 v32, v32
    v_exp_f32 v33, v33
    v_smfmac_f32_32x32x32_bf16 v[56:71], v[96:99], v[24:31], v7
    s_cmp_lt_u32 s75, 11
    s_setprio 0
    s_cbranch_scc1 Lpr38
    s_setprio 1
Lpr38:
    v_exp_f32 v34, v34
    v_exp_f32 v35, v35
    v_exp_f32 v36, v36
    v_exp_f32 v37, v37
    v_exp_f32 v38, v38
    v_exp_f32 v39, v39
    v_exp_f32 v8, v8
    v_exp_f32 v9, v9
    v_smfmac_f32_32x32x32_bf16 v[56:71], v[100:103], v[32:39], v7
    s_mov_b64 exec, s[44:45]
    ds_read_b128 v[96:99], v2 offset:48128
    ds_read_b128 v[100:103], v2 offset:48640
    s_mov_b64 exec, -1
    v_exp_f32 v10, v10
    v_exp_f32 v11, v11
    v_exp_f32 v12, v12
    v_mfma_f32_32x32x16_bf16 v[24:39], v[80:83], v[76:79], 0
    ds_read_b128 v[80:83], v250 offset:49152
    v_exp_f32 v13, v13
    v_exp_f32 v14, v14
    v_exp_f32 v15, v15
    v_exp_f32 v16, v16
    v_exp_f32 v17, v17
    v_smfmac_f32_32x32x32_bf16 v[40:55], v[88:91], v[8:15], v7
    s_waitcnt vmcnt(3)
    v_exp_f32 v18, v18
    v_exp_f32 v19, v19
    v_exp_f32 v20, v20
    v_mfma_f32_32x32x16_bf16 v[168:183], v[200:203], v[204:207], 0
    v_exp_f32 v21, v21
    v_exp_f32 v22, v22
    v_exp_f32 v23, v23
    v_exp_f32 v24, v24
    v_exp_f32 v25, v25
    v_smfmac_f32_32x32x32_bf16 v[40:55], v[92:95], v[16:23], v7
    s_waitcnt lgkmcnt(0)
    v_exp_f32 v26, v26
    v_exp_f32 v27, v27
    v_exp_f32 v28, v28
    v_mfma_f32_32x32x16_bf16 v[8:23], v[84:87], v[72:75], 0
    s_mov_b64 exec, 1
    ds_inc_u32 v1, v7
    ds_inc_u32 v1, v7 offset:8
    s_mov_b64 exec, -1
    v_exp_f32 v29, v29
    v_exp_f32 v30, v30
    v_exp_f32 v31, v31
    v_exp_f32 v32, v32
    v_exp_f32 v33, v33
    v_smfmac_f32_32x32x32_bf16 v[56:71], v[88:91], v[24:31], v7
    ds_read_b32 v6, v1 offset:4
    v_exp_f32 v34, v34
    v_exp_f32 v35, v35
    v_exp_f32 v36, v36
    v_mfma_f32_32x32x16_bf16 v[184:199], v[200:203], v[208:211], 0
    buffer_load_dwordx4 v[200:203], v3, s[12:15], s47 offen offset:2048 sc1
    buffer_load_dwordx4 v[204:207], v3, s[12:15], s64 offen offset:2048 sc1
    buffer_load_dwordx4 v[208:211], v3, s[12:15], s65 offen offset:2048 sc1
    v_exp_f32 v37, v37
    v_exp_f32 v38, v38
    v_exp_f32 v39, v39
    v_exp_f32 v8, v8
    v_exp_f32 v9, v9
    v_smfmac_f32_32x32x32_bf16 v[56:71], v[92:95], v[32:39], v7
    s_mov_b64 exec, s[44:45]
    ds_read_b128 v[88:91], v2 offset:50176
    ds_read_b128 v[92:95], v2 offset:50688
    s_mov_b64 exec, -1
    v_exp_f32 v10, v10
    v_exp_f32 v11, v11
    v_exp_f32 v12, v12
    v_mfma_f32_32x32x16_bf16 v[24:39], v[84:87], v[76:79], 0
    ds_read_b128 v[84:87], v250 offset:51200
    v_exp_f32 v13, v13
    v_exp_f32 v14, v14
    v_exp_f32 v15, v15
    v_exp_f32 v16, v16
    v_exp_f32 v17, v17
    v_smfmac_f32_32x32x32_bf16 v[40:55], v[96:99], v[8:15], v7
    s_waitcnt vmcnt(3)
    v_exp_f32 v18, v18
    v_exp_f32 v19, v19
    v_exp_f32 v20, v20
    v_mfma_f32_32x32x16_bf16 v[168:183], v[212:215], v[216:219], v[168:183]
    v_exp_f32 v21, v21
    v_exp_f32 v22, v22
    v_exp_f32 v23, v23
    v_exp_f32 v24, v24
    v_exp_f32 v25, v25
    v_smfmac_f32_32x32x32_bf16 v[40:55], v[100:103], v[16:23], v7
    s_waitcnt lgkmcnt(0)
    v_exp_f32 v26, v26
    v_exp_f32 v27, v27
    v_exp_f32 v28, v28
    v_mfma_f32_32x32x16_bf16 v[8:23], v[80:83], v[72:75], 0
    v_readfirstlane_b32 s75, v6
    v_exp_f32 v29, v29
    v_exp_f32 v30, v30
    v_exp_f32 v31, v31
    v_exp_f32 v32, v32
    v_exp_f32 v33, v33
    v_smfmac_f32_32x32x32_bf16 v[56:71], v[96:99], v[24:31], v7
    s_cmp_lt_u32 s75, 12
    s_setprio 0
    s_cbranch_scc1 Lpr39
    s_setprio 1
Lpr39:
    v_exp_f32 v34, v34
    v_exp_f32 v35, v35
    v_exp_f32 v36, v36
    v_mfma_f32_32x32x16_bf16 v[184:199], v[212:215], v[220:223], v[184:199]
    buffer_load_dwordx4 v[212:215], v3, s[12:15], s47 offen offset:3072 sc1
    buffer_load_dwordx4 v[216:219], v3, s[12:15], s64 offen offset:3072 sc1
    buffer_load_dwordx4 v[220:223], v3, s[12:15], s65 offen offset:3072 sc1
    s_add_u32 s47, s47, 4096
    s_add_u32 s64, s64, 4096
    s_add_u32 s65, s65, 4096
    v_exp_f32 v37, v37
    v_exp_f32 v38, v38
    v_exp_f32 v39, v39
    v_exp_f32 v8, v8
    v_exp_f32 v9, v9
    v_smfmac_f32_32x32x32_bf16 v[56:71], v[100:103], v[32:39], v7
    s_mov_b64 exec, s[44:45]
    ds_read_b128 v[96:99], v2 offset:52224
    ds_read_b128 v[100:103], v2 offset:52736
    s_mov_b64 exec, -1
    v_exp_f32 v10, v10
    v_exp_f32 v11, v11
    v_exp_f32 v12, v12
    v_mfma_f32_32x32x16_bf16 v[24:39], v[80:83], v[76:79], 0
    ds_read_b128 v[80:83], v250 offset:53248
    v_exp_f32 v13, v13
    v_exp_f32 v14, v14
    v_exp_f32 v15, v15
    v_exp_f32 v16, v16
    v_exp_f32 v17, v17
    v_smfmac_f32_32x32x32_bf16 v[40:55], v[88:91], v[8:15], v7
    s_waitcnt vmcnt(3)
    v_exp_f32 v18, v18
    v_exp_f32 v19, v19
    v_exp_f32 v20, v20
    v_mfma_f32_32x32x16_bf16 v[168:183], v[200:203], v[204:207], v[168:183]
    v_exp_f32 v21, v21
    v_exp_f32 v22, v22
    v_exp_f32 v23, v23
    v_exp_f32 v24, v24
    v_exp_f32 v25, v25
    v_smfmac_f32_32x32x32_bf16 v[40:55], v[92:95], v[16:23], v7
    s_waitcnt lgkmcnt(0)
    v_exp_f32 v26, v26
    v_exp_f32 v27, v27
    v_exp_f32 v28, v28
    v_mfma_f32_32x32x16_bf16 v[8:23], v[84:87], v[72:75], 0
    s_mov_b64 exec, 1
    ds_inc_u32 v1, v7
    ds_inc_u32 v1, v7 offset:8
    s_mov_b64 exec, -1
    v_exp_f32 v29, v29
    v_exp_f32 v30, v30
    v_exp_f32 v31, v31
    v_exp_f32 v32, v32
    v_exp_f32 v33, v33
    v_smfmac_f32_32x32x32_bf16 v[56:71], v[88:91], v[24:31], v7
    ds_read_b32 v6, v1 offset:4
    v_exp_f32 v34, v34
    v_exp_f32 v35, v35
    v_exp_f32 v36, v36
    v_mfma_f32_32x32x16_bf16 v[184:199], v[200:203], v[208:211], v[184:199]
    buffer_load_dwordx4 v[200:203], v3, s[12:15], s47 offen offset:0 sc1
    buffer_load_dwordx4 v[204:207], v3, s[12:15], s64 offen offset:0 sc1
    buffer_load_dwordx4 v[208:211], v3, s[12:15], s65 offen offset:0 sc1
    v_exp_f32 v37, v37
    v_exp_f32 v38, v38
    v_exp_f32 v39, v39
    v_exp_f32 v8, v8
    v_exp_f32 v9, v9
    v_smfmac_f32_32x32x32_bf16 v[56:71], v[92:95], v[32:39], v7
    s_mov_b64 exec, s[44:45]
    ds_read_b128 v[88:91], v2 offset:54272
    ds_read_b128 v[92:95], v2 offset:54784
    s_mov_b64 exec, -1
    v_exp_f32 v10, v10
    v_exp_f32 v11, v11
    v_exp_f32 v12, v12
    v_mfma_f32_32x32x16_bf16 v[24:39], v[84:87], v[76:79], 0
    ds_read_b128 v[84:87], v250 offset:55296
    v_exp_f32 v13, v13
    v_exp_f32 v14, v14
    v_exp_f32 v15, v15
    v_exp_f32 v16, v16
    v_exp_f32 v17, v17
    v_smfmac_f32_32x32x32_bf16 v[40:55], v[96:99], v[8:15], v7
    s_waitcnt vmcnt(3)
    v_exp_f32 v18, v18
    v_exp_f32 v19, v19
    v_exp_f32 v20, v20
    v_mfma_f32_32x32x16_bf16 v[168:183], v[212:215], v[216:219], v[168:183]
    v_exp_f32 v21, v21
    v_exp_f32 v22, v22
    v_exp_f32 v23, v23
    v_exp_f32 v24, v24
    v_exp_f32 v25, v25
    v_smfmac_f32_32x32x32_bf16 v[40:55], v[100:103], v[16:23], v7
    s_waitcnt lgkmcnt(0)
    v_exp_f32 v26, v26
    v_exp_f32 v27, v27
    v_exp_f32 v28, v28
    v_mfma_f32_32x32x16_bf16 v[8:23], v[80:83], v[72:75], 0
    v_readfirstlane_b32 s75, v6
    v_exp_f32 v29, v29
    v_exp_f32 v30, v30
    v_exp_f32 v31, v31
    v_exp_f32 v32, v32
    v_exp_f32 v33, v33
    v_smfmac_f32_32x32x32_bf16 v[56:71], v[96:99], v[24:31], v7
    s_cmp_lt_u32 s75, 13
    s_setprio 0
    s_cbranch_scc1 Lpr40
    s_setprio 1
Lpr40:
    v_exp_f32 v34, v34
    v_exp_f32 v35, v35
    v_exp_f32 v36, v36
    v_mfma_f32_32x32x16_bf16 v[184:199], v[212:215], v[220:223], v[184:199]
    buffer_load_dwordx4 v[212:215], v3, s[12:15], s47 offen offset:1024 sc1
    buffer_load_dwordx4 v[216:219], v3, s[12:15], s64 offen offset:1024 sc1
    buffer_load_dwordx4 v[220:223], v3, s[12:15], s65 offen offset:1024 sc1
    v_exp_f32 v37, v37
    v_exp_f32 v38, v38
    v_exp_f32 v39, v39
    v_exp_f32 v8, v8
    v_exp_f32 v9, v9
    v_smfmac_f32_32x32x32_bf16 v[56:71], v[100:103], v[32:39], v7
    s_mov_b64 exec, s[44:45]
    ds_read_b128 v[96:99], v2 offset:56320
    ds_read_b128 v[100:103], v2 offset:56832
    s_mov_b64 exec, -1
    v_exp_f32 v10, v10
    v_exp_f32 v11, v11
    v_exp_f32 v12, v12
    v_mfma_f32_32x32x16_bf16 v[24:39], v[80:83], v[76:79], 0
    ds_read_b128 v[80:83], v250 offset:57344
    v_exp_f32 v13, v13
    v_exp_f32 v14, v14
    v_exp_f32 v15, v15
    v_exp_f32 v16, v16
    v_exp_f32 v17, v17
    v_smfmac_f32_32x32x32_bf16 v[40:55], v[88:91], v[8:15], v7
    s_waitcnt vmcnt(3)
    v_exp_f32 v18, v18
    v_exp_f32 v19, v19
    v_exp_f32 v20, v20
    v_mfma_f32_32x32x16_bf16 v[168:183], v[200:203], v[204:207], v[168:183]
    v_exp_f32 v21, v21
    v_exp_f32 v22, v22
    v_exp_f32 v23, v23
    v_exp_f32 v24, v24
    v_exp_f32 v25, v25
    v_smfmac_f32_32x32x32_bf16 v[40:55], v[92:95], v[16:23], v7
    s_waitcnt lgkmcnt(0)
    v_exp_f32 v26, v26
    v_exp_f32 v27, v27
    v_exp_f32 v28, v28
    v_mfma_f32_32x32x16_bf16 v[8:23], v[84:87], v[72:75], 0
    s_mov_b64 exec, 1
    ds_inc_u32 v1, v7
    ds_inc_u32 v1, v7 offset:8
    s_mov_b64 exec, -1
    v_exp_f32 v29, v29
    v_exp_f32 v30, v30
    v_exp_f32 v31, v31
    v_exp_f32 v32, v32
    v_exp_f32 v33, v33
    v_smfmac_f32_32x32x32_bf16 v[56:71], v[88:91], v[24:31], v7
    ds_read_b32 v6, v1 offset:4
    v_exp_f32 v34, v34
    v_exp_f32 v35, v35
    v_exp_f32 v36, v36
    v_mfma_f32_32x32x16_bf16 v[184:199], v[200:203], v[208:211], v[184:199]
    buffer_load_dwordx4 v[200:203], v3, s[12:15], s47 offen offset:2048 sc1
    buffer_load_dwordx4 v[204:207], v3, s[12:15], s64 offen offset:2048 sc1
    buffer_load_dwordx4 v[208:211], v3, s[12:15], s65 offen offset:2048 sc1
    v_exp_f32 v37, v37
    v_exp_f32 v38, v38
    v_exp_f32 v39, v39
    v_exp_f32 v8, v8
    v_exp_f32 v9, v9
    v_smfmac_f32_32x32x32_bf16 v[56:71], v[92:95], v[32:39], v7
    s_mov_b64 exec, s[44:45]
    ds_read_b128 v[88:91], v2 offset:58368
    ds_read_b128 v[92:95], v2 offset:58880
    s_mov_b64 exec, -1
    v_exp_f32 v10, v10
    v_exp_f32 v11, v11
    v_exp_f32 v12, v12
    v_mfma_f32_32x32x16_bf16 v[24:39], v[84:87], v[76:79], 0
    ds_read_b128 v[84:87], v250 offset:59392
    v_exp_f32 v13, v13
    v_exp_f32 v14, v14
    v_exp_f32 v15, v15
    v_exp_f32 v16, v16
    v_exp_f32 v17, v17
    v_smfmac_f32_32x32x32_bf16 v[40:55], v[96:99], v[8:15], v7
    s_waitcnt vmcnt(3)
    v_exp_f32 v18, v18
    v_exp_f32 v19, v19
    v_exp_f32 v20, v20
    v_mfma_f32_32x32x16_bf16 v[168:183], v[212:215], v[216:219], v[168:183]
    v_exp_f32 v21, v21
    v_exp_f32 v22, v22
    v_exp_f32 v23, v23
    v_exp_f32 v24, v24
    v_exp_f32 v25, v25
    v_smfmac_f32_32x32x32_bf16 v[40:55], v[100:103], v[16:23], v7
    s_waitcnt lgkmcnt(0)
    v_exp_f32 v26, v26
    v_exp_f32 v27, v27
    v_exp_f32 v28, v28
    v_mfma_f32_32x32x16_bf16 v[8:23], v[80:83], v[72:75], 0
    v_readfirstlane_b32 s75, v6
    v_exp_f32 v29, v29
    v_exp_f32 v30, v30
    v_exp_f32 v31, v31
    v_exp_f32 v32, v32
    v_exp_f32 v33, v33
    v_smfmac_f32_32x32x32_bf16 v[56:71], v[96:99], v[24:31], v7
    s_cmp_lt_u32 s75, 14
    s_setprio 0
    s_cbranch_scc1 Lpr41
    s_setprio 1
Lpr41:
    v_exp_f32 v34, v34
    v_exp_f32 v35, v35
    v_exp_f32 v36, v36
    v_mfma_f32_32x32x16_bf16 v[184:199], v[212:215], v[220:223], v[184:199]
    buffer_load_dwordx4 v[212:215], v3, s[12:15], s47 offen offset:3072 sc1
    buffer_load_dwordx4 v[216:219], v3, s[12:15], s64 offen offset:3072 sc1
    buffer_load_dwordx4 v[220:223], v3, s[12:15], s65 offen offset:3072 sc1
    s_add_u32 s47, s47, 4096
    s_add_u32 s64, s64, 4096
    s_add_u32 s65, s65, 4096
    v_exp_f32 v37, v37
    v_exp_f32 v38, v38
    v_exp_f32 v39, v39
    v_exp_f32 v8, v8
    v_exp_f32 v9, v9
    v_smfmac_f32_32x32x32_bf16 v[56:71], v[100:103], v[32:39], v7
    s_mov_b64 exec, s[44:45]
    ds_read_b128 v[96:99], v2 offset:60416
    ds_read_b128 v[100:103], v2 offset:60928
    s_mov_b64 exec, -1
    v_exp_f32 v10, v10
    v_exp_f32 v11, v11
    v_exp_f32 v12, v12
    v_mfma_f32_32x32x16_bf16 v[24:39], v[80:83], v[76:79], 0
    ds_read_b128 v[80:83], v250 offset:61440
    v_exp_f32 v13, v13
    v_exp_f32 v14, v14
    v_exp_f32 v15, v15
    v_exp_f32 v16, v16
    v_exp_f32 v17, v17
    v_smfmac_f32_32x32x32_bf16 v[40:55], v[88:91], v[8:15], v7
    s_waitcnt vmcnt(3)
    v_exp_f32 v18, v18
    v_exp_f32 v19, v19
    v_exp_f32 v20, v20
    v_mfma_f32_32x32x16_bf16 v[168:183], v[200:203], v[204:207], v[168:183]
    v_exp_f32 v21, v21
    v_exp_f32 v22, v22
    v_exp_f32 v23, v23
    v_exp_f32 v24, v24
    v_exp_f32 v25, v25
    v_smfmac_f32_32x32x32_bf16 v[40:55], v[92:95], v[16:23], v7
    s_waitcnt lgkmcnt(0)
    v_exp_f32 v26, v26
    v_exp_f32 v27, v27
    v_exp_f32 v28, v28
    v_mfma_f32_32x32x16_bf16 v[8:23], v[84:87], v[72:75], 0
    s_mov_b64 exec, 1
    ds_inc_u32 v1, v7
    ds_inc_u32 v1, v7 offset:8
    s_mov_b64 exec, -1
    v_exp_f32 v29, v29
    v_exp_f32 v30, v30
    v_exp_f32 v31, v31
    v_exp_f32 v32, v32
    v_exp_f32 v33, v33
    v_smfmac_f32_32x32x32_bf16 v[56:71], v[88:91], v[24:31], v7
    ds_read_b32 v6, v1 offset:4
    v_exp_f32 v34, v34
    v_exp_f32 v35, v35
    v_exp_f32 v36, v36
    v_mfma_f32_32x32x16_bf16 v[184:199], v[200:203], v[208:211], v[184:199]
    buffer_load_dwordx4 v[200:203], v3, s[12:15], s47 offen offset:0 sc1
    buffer_load_dwordx4 v[204:207], v3, s[12:15], s64 offen offset:0 sc1
    buffer_load_dwordx4 v[208:211], v3, s[12:15], s65 offen offset:0 sc1
    v_exp_f32 v37, v37
    v_exp_f32 v38, v38
    v_exp_f32 v39, v39
    v_exp_f32 v8, v8
    v_exp_f32 v9, v9
    v_smfmac_f32_32x32x32_bf16 v[56:71], v[92:95], v[32:39], v7
    s_mov_b64 exec, s[44:45]
    ds_read_b128 v[88:91], v2 offset:62464
    ds_read_b128 v[92:95], v2 offset:62976
    s_mov_b64 exec, -1
    v_exp_f32 v10, v10
    v_exp_f32 v11, v11
    v_exp_f32 v12, v12
    v_mfma_f32_32x32x16_bf16 v[24:39], v[84:87], v[76:79], 0
    ds_read_b128 v[84:87], v250 offset:63488
    v_exp_f32 v13, v13
    v_exp_f32 v14, v14
    v_exp_f32 v15, v15
    v_exp_f32 v16, v16
    v_exp_f32 v17, v17
    v_smfmac_f32_32x32x32_bf16 v[40:55], v[96:99], v[8:15], v7
    s_waitcnt vmcnt(3)
    v_exp_f32 v18, v18
    v_exp_f32 v19, v19
    v_exp_f32 v20, v20
    v_mfma_f32_32x32x16_bf16 v[168:183], v[212:215], v[216:219], v[168:183]
    v_exp_f32 v21, v21
    v_exp_f32 v22, v22
    v_exp_f32 v23, v23
    v_exp_f32 v24, v24
    v_exp_f32 v25, v25
    v_smfmac_f32_32x32x32_bf16 v[40:55], v[100:103], v[16:23], v7
    s_waitcnt lgkmcnt(0)
    v_exp_f32 v26, v26
    v_exp_f32 v27, v27
    v_exp_f32 v28, v28
    v_mfma_f32_32x32x16_bf16 v[8:23], v[80:83], v[72:75], 0
    v_readfirstlane_b32 s75, v6
    v_exp_f32 v29, v29
    v_exp_f32 v30, v30
    v_exp_f32 v31, v31
    v_exp_f32 v32, v32
    v_exp_f32 v33, v33
    v_smfmac_f32_32x32x32_bf16 v[56:71], v[96:99], v[24:31], v7
    s_cmp_lt_u32 s75, 15
    s_setprio 0
    s_cbranch_scc1 Lpr42
    s_setprio 1
Lpr42:
    v_exp_f32 v34, v34
    v_exp_f32 v35, v35
    v_exp_f32 v36, v36
    v_mfma_f32_32x32x16_bf16 v[184:199], v[212:215], v[220:223], v[184:199]
    buffer_load_dwordx4 v[212:215], v3, s[12:15], s47 offen offset:1024 sc1
    buffer_load_dwordx4 v[216:219], v3, s[12:15], s64 offen offset:1024 sc1
    buffer_load_dwordx4 v[220:223], v3, s[12:15], s65 offen offset:1024 sc1
    v_exp_f32 v37, v37
    v_exp_f32 v38, v38
    v_exp_f32 v39, v39
    v_exp_f32 v8, v8
    v_exp_f32 v9, v9
    v_smfmac_f32_32x32x32_bf16 v[56:71], v[100:103], v[32:39], v7
    s_mov_b64 exec, s[44:45]
    ds_read_b128 v[96:99], v2 offset:64512
    ds_read_b128 v[100:103], v2 offset:65024
    s_mov_b64 exec, -1
    v_exp_f32 v10, v10
    v_exp_f32 v11, v11
    v_exp_f32 v12, v12
    v_mfma_f32_32x32x16_bf16 v[24:39], v[80:83], v[76:79], 0
    v_exp_f32 v13, v13
    v_exp_f32 v14, v14
    v_exp_f32 v15, v15
    v_exp_f32 v16, v16
    v_exp_f32 v17, v17
    v_smfmac_f32_32x32x32_bf16 v[40:55], v[88:91], v[8:15], v7
    s_waitcnt vmcnt(3)
    v_exp_f32 v18, v18
    v_exp_f32 v19, v19
    v_exp_f32 v20, v20
    v_mfma_f32_32x32x16_bf16 v[168:183], v[200:203], v[204:207], v[168:183]
    v_exp_f32 v21, v21
    v_exp_f32 v22, v22
    v_exp_f32 v23, v23
    v_exp_f32 v24, v24
    v_exp_f32 v25, v25
    v_smfmac_f32_32x32x32_bf16 v[40:55], v[92:95], v[16:23], v7
    s_waitcnt lgkmcnt(0)
    v_exp_f32 v26, v26
    v_exp_f32 v27, v27
    v_exp_f32 v28, v28
    v_mfma_f32_32x32x16_bf16 v[8:23], v[84:87], v[72:75], 0
    v_exp_f32 v29, v29
    v_exp_f32 v30, v30
    v_exp_f32 v31, v31
    v_exp_f32 v32, v32
    v_exp_f32 v33, v33
    v_smfmac_f32_32x32x32_bf16 v[56:71], v[88:91], v[24:31], v7
    v_exp_f32 v34, v34
    v_exp_f32 v35, v35
    v_exp_f32 v36, v36
    v_mfma_f32_32x32x16_bf16 v[184:199], v[200:203], v[208:211], v[184:199]
    buffer_load_dwordx4 v[200:203], v3, s[12:15], s47 offen offset:2048 sc1
    buffer_load_dwordx4 v[204:207], v3, s[12:15], s64 offen offset:2048 sc1
    buffer_load_dwordx4 v[208:211], v3, s[12:15], s65 offen offset:2048 sc1
    v_exp_f32 v37, v37
    v_exp_f32 v38, v38
    v_exp_f32 v39, v39
    v_exp_f32 v8, v8
    v_exp_f32 v9, v9
    v_smfmac_f32_32x32x32_bf16 v[56:71], v[92:95], v[32:39], v7
    v_exp_f32 v10, v10
    v_exp_f32 v11, v11
    v_exp_f32 v12, v12
    v_mfma_f32_32x32x16_bf16 v[24:39], v[84:87], v[76:79], 0
    v_exp_f32 v13, v13
    v_exp_f32 v14, v14
    v_exp_f32 v15, v15
    v_exp_f32 v16, v16
    v_exp_f32 v17, v17
    v_smfmac_f32_32x32x32_bf16 v[40:55], v[96:99], v[8:15], v7
    s_waitcnt vmcnt(3)
    v_exp_f32 v18, v18
    v_exp_f32 v19, v19
    v_exp_f32 v20, v20
    v_mfma_f32_32x32x16_bf16 v[168:183], v[212:215], v[216:219], v[168:183]
    v_exp_f32 v21, v21
    v_exp_f32 v22, v22
    v_exp_f32 v23, v23
    v_exp_f32 v24, v24
    v_exp_f32 v25, v25
    v_smfmac_f32_32x32x32_bf16 v[40:55], v[100:103], v[16:23], v7
    s_waitcnt lgkmcnt(0)
    v_exp_f32 v26, v26
    v_exp_f32 v27, v27
    v_exp_f32 v28, v28
    v_exp_f32 v29, v29
    v_exp_f32 v30, v30
    v_exp_f32 v31, v31
    v_exp_f32 v32, v32
    v_exp_f32 v33, v33
    v_smfmac_f32_32x32x32_bf16 v[56:71], v[96:99], v[24:31], v7
    v_exp_f32 v34, v34
    v_exp_f32 v35, v35
    v_exp_f32 v36, v36
    v_mfma_f32_32x32x16_bf16 v[184:199], v[212:215], v[220:223], v[184:199]
    buffer_load_dwordx4 v[212:215], v3, s[12:15], s47 offen offset:3072 sc1
    buffer_load_dwordx4 v[216:219], v3, s[12:15], s64 offen offset:3072 sc1
    buffer_load_dwordx4 v[220:223], v3, s[12:15], s65 offen offset:3072 sc1
    s_add_u32 s47, s47, 4096
    s_add_u32 s64, s64, 4096
    s_add_u32 s65, s65, 4096
    v_exp_f32 v37, v37
    v_exp_f32 v38, v38
    v_exp_f32 v39, v39
    s_nop 1
    v_smfmac_f32_32x32x32_bf16 v[56:71], v[100:103], v[32:39], v7
    s_mov_b32 s62, s47
    s_mov_b32 s63, s64
    s_mov_b32 s75, s65
    buffer_load_dwordx4 v[8:11], v3, s[12:15], s47 offen offset:0 sc1
    buffer_load_dwordx4 v[12:15], v3, s[12:15], s64 offen offset:0 sc1
    buffer_load_dwordx4 v[16:19], v3, s[12:15], s65 offen offset:0 sc1
    buffer_load_dwordx4 v[20:23], v3, s[12:15], s47 offen offset:1024 sc1
    buffer_load_dwordx4 v[24:27], v3, s[12:15], s64 offen offset:1024 sc1
    buffer_load_dwordx4 v[28:31], v3, s[12:15], s65 offen offset:1024 sc1
    buffer_load_dwordx4 v[72:75], v3, s[12:15], s47 offen offset:2048 sc1
    buffer_load_dwordx4 v[76:79], v3, s[12:15], s64 offen offset:2048 sc1
    buffer_load_dwordx4 v[80:83], v3, s[12:15], s65 offen offset:2048 sc1
    s_mul_i32 s68, s3, 2304
    s_add_u32 s68, s68, 65536
    v_add_u32 v4, s68, v3
    v_lshl_add_u32 v5, v0, 2, s68
    s_xor_b32 s68, s3, 4
    s_mul_i32 s68, s68, 2304
    s_add_u32 s68, s68, 65536
    v_add_u32 v251, s68, v3
    v_lshl_add_u32 v252, v0, 2, s68
    v_sub_f32 v249, 1.0, v249
    s_cmp_eq_u32 s5, 0
    s_cbranch_scc0 L_red1
    ds_write_b128 v4, v[56:59]
    ds_write_b128 v4, v[60:63] offset:1024
    ds_write_b32 v5, v64 offset:2048
    s_branch L_red2
L_red1:
    ds_write_b128 v4, v[40:43]
    ds_write_b128 v4, v[44:47] offset:1024
    ds_write_b32 v5, v48 offset:2048
    s_waitcnt lgkmcnt(0)
    v_mov_b32 v40, v56
    v_mov_b32 v41, v57
    v_mov_b32 v42, v58
    v_mov_b32 v43, v59
    v_mov_b32 v44, v60
    v_mov_b32 v45, v61
    v_mov_b32 v46, v62
    v_mov_b32 v47, v63
    v_mov_b32 v48, v64
L_red2:
    v_cvt_pk_bf16_f32 v249, v249, v249
    s_lshl_b32 s70, s46, 15
    s_lshl_b32 s71, s36, 10
    s_add_u32 s70, s70, s71
    s_add_u32 s70, s70, 16785408
    v_and_b32 v249, 0xffff0000, v249
    s_mov_b32 s68, 0x2b800000
    s_mov_b32 s69, 0x53800000
    s_mov_b32 s42, 0x7b800000
    s_waitcnt lgkmcnt(0)
    buffer_load_dwordx4 v[56:59], v3, s[12:15], s47 offen offset:3072 sc1
    buffer_load_dwordx4 v[60:63], v3, s[12:15], s64 offen offset:3072 sc1
    buffer_load_dwordx4 v[64:67], v3, s[12:15], s65 offen offset:3072 sc1
    s_add_u32 s47, s47, 4096
    s_add_u32 s64, s64, 4096
    s_add_u32 s65, s65, 4096
    s_barrier
    ds_read_b128 v[96:99], v251
    ds_read_b128 v[100:103], v251 offset:1024
    ds_read_b32 v84, v252 offset:2048
    s_waitcnt lgkmcnt(0)
    v_add_f32 v40, v40, v96
    v_add_f32 v41, v41, v97
    v_add_f32 v42, v42, v98
    v_add_f32 v43, v43, v99
    v_add_f32 v44, v44, v100
    v_add_f32 v45, v45, v101
    v_add_f32 v46, v46, v102
    v_add_f32 v47, v47, v103
    v_add_f32 v48, v48, v84
    v_max3_f32 v6, |v40|, |v41|, |v42|
    v_max3_f32 v6, v6, |v43|, |v44|
    v_max3_f32 v6, v6, |v45|, |v46|
    v_max_f32 v6, v6, |v47|
    v_cmp_le_f32 s[78:79], s68, v48
    v_cmp_ge_f32 s[80:81], s69, v48
    v_cmp_ge_f32 vcc, s42, v6
    s_and_b64 s[78:79], s[78:79], s[80:81]
    s_and_b64 s[78:79], s[78:79], vcc
    s_cmp_eq_u64 s[78:79], -1
    s_cbranch_scc0 L_slow
L_fin:
    v_rcp_f32 v6, v48
    s_nop 0
    v_mul_f32 v6, v249, v6
    v_mul_f32 v40, v6, v40
    v_mul_f32 v41, v6, v41
    v_mul_f32 v42, v6, v42
    v_mul_f32 v43, v6, v43
    v_mul_f32 v44, v6, v44
    v_mul_f32 v45, v6, v45
    v_mul_f32 v46, v6, v46
    v_mul_f32 v47, v6, v47
    v_cvt_pk_bf16_f32 v88, v40, v41
    v_cvt_pk_bf16_f32 v89, v42, v43
    v_cvt_pk_bf16_f32 v90, v44, v45
    v_cvt_pk_bf16_f32 v91, v46, v47
    v_min_u32 v88, -2, v88
    v_min_u32 v89, -2, v89
    v_min_u32 v90, -2, v90
    v_min_u32 v91, -2, v91
    buffer_store_dwordx4 v[88:91], v3, s[12:15], s70 offen sc1
    s_lshl_b32 s47, s49, 15
    s_lshl_b32 s74, s4, 13
    s_add_u32 s47, s47, s74
    s_add_u32 s47, s47, 16785408
    s_add_u32 s48, s47, 4096
    s_waitcnt vmcnt(16)
    v_mfma_f32_32x32x16_bf16 v[168:183], v[200:203], v[204:207], v[168:183]
    v_mfma_f32_32x32x16_bf16 v[184:199], v[200:203], v[208:211], v[184:199]
    s_waitcnt vmcnt(13)
    v_mfma_f32_32x32x16_bf16 v[168:183], v[212:215], v[216:219], v[168:183]
    v_mfma_f32_32x32x16_bf16 v[184:199], v[212:215], v[220:223], v[184:199]
    s_waitcnt vmcnt(10)
    v_mfma_f32_32x32x16_bf16 v[168:183], v[8:11], v[12:15], v[168:183]
    v_mfma_f32_32x32x16_bf16 v[184:199], v[8:11], v[16:19], v[184:199]
    s_waitcnt vmcnt(7)
    v_mfma_f32_32x32x16_bf16 v[168:183], v[20:23], v[24:27], v[168:183]
    v_mfma_f32_32x32x16_bf16 v[184:199], v[20:23], v[28:31], v[184:199]
    s_waitcnt vmcnt(4)
    v_mfma_f32_32x32x16_bf16 v[168:183], v[72:75], v[76:79], v[168:183]
    v_mfma_f32_32x32x16_bf16 v[184:199], v[72:75], v[80:83], v[184:199]
    s_waitcnt vmcnt(1)
    v_mfma_f32_32x32x16_bf16 v[168:183], v[56:59], v[60:63], v[168:183]
    v_mfma_f32_32x32x16_bf16 v[184:199], v[56:59], v[64:67], v[184:199]
    v_lshlrev_b32 v248, 16, v248
    v_lshlrev_b32 v240, 16, v240
    v_mul_f32 v240, v248, v240
    v_lshlrev_b32 v241, 16, v241
    v_mul_f32 v241, v248, v241
    v_lshlrev_b32 v242, 16, v242
    v_mul_f32 v242, v248, v242
    v_lshlrev_b32 v243, 16, v243
    v_mul_f32 v243, v248, v243
    v_lshlrev_b32 v244, 16, v244
    v_mul_f32 v244, v248, v244
    v_lshlrev_b32 v245, 16, v245
    v_mul_f32 v245, v248, v245
    v_lshlrev_b32 v246, 16, v246
    v_mul_f32 v246, v248, v246
    v_lshlrev_b32 v247, 16, v247
    v_mul_f32 v247, v248, v247
    v_cvt_pk_bf16_f32 v40, v240, v241
    v_cvt_pk_bf16_f32 v41, v242, v243
    v_cvt_pk_bf16_f32 v42, v244, v245
    v_cvt_pk_bf16_f32 v43, v246, v247
    s_bitcmp1_b32 s4, 0
    s_cselect_b64 vcc, -1, 0
    v_lshlrev_b32 v240, 16, v40
    v_and_b32 v241, 0xffff0000, v40
    v_lshlrev_b32 v242, 16, v41
    v_and_b32 v243, 0xffff0000, v41
    v_lshlrev_b32 v244, 16, v42
    v_and_b32 v245, 0xffff0000, v42
    v_lshlrev_b32 v246, 16, v43
    v_and_b32 v247, 0xffff0000, v43
    v_cndmask_b32 v44, v224, v232, vcc
    v_cndmask_b32 v45, v225, v233, vcc
    v_cndmask_b32 v46, v226, v234, vcc
    v_cndmask_b32 v47, v227, v235, vcc
    v_cndmask_b32 v48, v228, v236, vcc
    v_cndmask_b32 v49, v229, v237, vcc
    v_cndmask_b32 v50, v230, v238, vcc
    v_cndmask_b32 v51, v231, v239, vcc
    v_mul_f32 v240, v44, v240
    v_mul_f32 v241, v45, v241
    v_mul_f32 v242, v46, v242
    v_mul_f32 v243, v47, v243
    v_mul_f32 v244, v48, v244
    v_mul_f32 v245, v49, v245
    v_mul_f32 v246, v50, v246
    v_mul_f32 v247, v51, v247
    v_mul_f32 v168, v224, v168
    v_mul_f32 v169, v225, v169
    v_mul_f32 v170, v226, v170
    v_mul_f32 v171, v227, v171
    v_mul_f32 v172, v228, v172
    v_mul_f32 v173, v229, v173
    v_mul_f32 v174, v230, v174
    v_mul_f32 v175, v231, v175
    v_mul_f32 v176, v232, v176
    v_mul_f32 v177, v233, v177
    v_mul_f32 v178, v234, v178
    v_mul_f32 v179, v235, v179
    v_mul_f32 v180, v236, v180
    v_mul_f32 v181, v237, v181
    v_mul_f32 v182, v238, v182
    v_mul_f32 v183, v239, v183
    v_mul_f32 v184, v224, v184
    v_mul_f32 v185, v225, v185
    v_mul_f32 v186, v226, v186
    v_mul_f32 v187, v227, v187
    v_mul_f32 v188, v228, v188
    v_mul_f32 v189, v229, v189
    v_mul_f32 v190, v230, v190
    v_mul_f32 v191, v231, v191
    v_mul_f32 v192, v232, v192
    v_mul_f32 v193, v233, v193
    v_mul_f32 v194, v234, v194
    v_mul_f32 v195, v235, v195
    v_mul_f32 v196, v236, v196
    v_mul_f32 v197, v237, v197
    v_mul_f32 v198, v238, v198
    v_mul_f32 v199, v239, v199
    s_lshl_b32 s68, s3, 13
    v_add_u32 v232, s68, v3
    s_lshl_b32 s68, s5, 15
    s_lshl_b32 s74, s4, 11
    s_add_u32 s68, s68, s74
    v_add_u32 v233, s68, v3
    v_lshrrev_b32 v4, 5, v0
    v_and_b32 v5, 31, v0
    v_lshlrev_b32 v5, 2, v5
    v_lshl_add_u32 v234, v4, 15, v5
    v_add_u32 v235, 4096, v234
    s_lshl_b32 s40, s40, 11
    s_lshl_b32 s41, s41, 2
    s_add_u32 s40, s40, s41
    s_add_u32 s41, s40, 8192
    s_mov_b32 s28, s66
    s_mov_b32 s29, s67
    s_mov_b32 s30, 0x400000
    s_mov_b32 s31, 0x00020000
    s_waitcnt vmcnt(0)
    buffer_load_dwordx4 v[8:11], v3, s[12:15], s47 offen offset:0 sc1
    buffer_load_dwordx4 v[12:15], v3, s[12:15], s47 offen offset:1024 sc1
    buffer_load_dwordx4 v[16:19], v3, s[12:15], s47 offen offset:2048 sc1
    buffer_load_dwordx4 v[20:23], v3, s[12:15], s47 offen offset:3072 sc1
    buffer_load_dwordx4 v[24:27], v3, s[12:15], s48 offen offset:0 sc1
    buffer_load_dwordx4 v[28:31], v3, s[12:15], s48 offen offset:1024 sc1
    buffer_load_dwordx4 v[32:35], v3, s[12:15], s48 offen offset:2048 sc1
    buffer_load_dwordx4 v[36:39], v3, s[12:15], s48 offen offset:3072 sc1
    s_mov_b32 s81, 400000
L_opoll:
    s_waitcnt vmcnt(7)
    v_mfma_f32_32x32x16_bf16 v[40:55], v[8:11], v[104:107], v[168:183]
    v_mfma_f32_32x32x16_bf16 v[56:71], v[8:11], v[108:111], v[184:199]
    v_max3_u32 v4, v8, v9, v10
    v_max_u32 v4, v4, v11
    s_waitcnt vmcnt(6)
    v_mfma_f32_32x32x16_bf16 v[40:55], v[12:15], v[112:115], v[40:55]
    v_mfma_f32_32x32x16_bf16 v[56:71], v[12:15], v[116:119], v[56:71]
    v_max3_u32 v4, v4, v12, v13
    v_max3_u32 v4, v4, v14, v15
    s_waitcnt vmcnt(5)
    v_mfma_f32_32x32x16_bf16 v[40:55], v[16:19], v[120:123], v[40:55]
    v_mfma_f32_32x32x16_bf16 v[56:71], v[16:19], v[124:127], v[56:71]
    v_max3_u32 v4, v4, v16, v17
    v_max3_u32 v4, v4, v18, v19
    s_waitcnt vmcnt(4)
    v_mfma_f32_32x32x16_bf16 v[40:55], v[20:23], v[128:131], v[40:55]
    v_mfma_f32_32x32x16_bf16 v[56:71], v[20:23], v[132:135], v[56:71]
    v_max3_u32 v4, v4, v20, v21
    v_max3_u32 v4, v4, v22, v23
    s_waitcnt vmcnt(3)
    v_mfma_f32_32x32x16_bf16 v[40:55], v[24:27], v[136:139], v[40:55]
    v_mfma_f32_32x32x16_bf16 v[56:71], v[24:27], v[140:143], v[56:71]
    v_max3_u32 v4, v4, v24, v25
    v_max3_u32 v4, v4, v26, v27
    s_waitcnt vmcnt(2)
    v_mfma_f32_32x32x16_bf16 v[40:55], v[28:31], v[144:147], v[40:55]
    v_mfma_f32_32x32x16_bf16 v[56:71], v[28:31], v[148:151], v[56:71]
    v_max3_u32 v4, v4, v28, v29
    v_max3_u32 v4, v4, v30, v31
    s_waitcnt vmcnt(1)
    v_mfma_f32_32x32x16_bf16 v[40:55], v[32:35], v[152:155], v[40:55]
    v_mfma_f32_32x32x16_bf16 v[56:71], v[32:35], v[156:159], v[56:71]
    v_max3_u32 v4, v4, v32, v33
    v_max3_u32 v4, v4, v34, v35
    s_waitcnt vmcnt(0)
    v_mfma_f32_32x32x16_bf16 v[40:55], v[36:39], v[160:163], v[40:55]
    v_mfma_f32_32x32x16_bf16 v[56:71], v[36:39], v[164:167], v[56:71]
    v_max3_u32 v4, v4, v36, v37
    v_max3_u32 v4, v4, v38, v39
    v_cmp_eq_u32 s[78:79], -1, v4
    s_sub_u32 s81, s81, 1
    s_cbranch_scc1 L_opollx
    s_cmp_eq_u64 s[78:79], 0
    s_cbranch_scc1 L_opollx
    s_sleep 1
    buffer_load_dwordx4 v[8:11], v3, s[12:15], s47 offen offset:0 sc1
    buffer_load_dwordx4 v[12:15], v3, s[12:15], s47 offen offset:1024 sc1
    buffer_load_dwordx4 v[16:19], v3, s[12:15], s47 offen offset:2048 sc1
    buffer_load_dwordx4 v[20:23], v3, s[12:15], s47 offen offset:3072 sc1
    buffer_load_dwordx4 v[24:27], v3, s[12:15], s48 offen offset:0 sc1
    buffer_load_dwordx4 v[28:31], v3, s[12:15], s48 offen offset:1024 sc1
    buffer_load_dwordx4 v[32:35], v3, s[12:15], s48 offen offset:2048 sc1
    buffer_load_dwordx4 v[36:39], v3, s[12:15], s48 offen offset:3072 sc1
    s_branch L_opoll
L_opollx:
    s_nop 5
    ds_write_b128 v232, v[40:43] offset:0
    ds_write_b128 v232, v[44:47] offset:1024
    ds_write_b128 v232, v[48:51] offset:2048
    ds_write_b128 v232, v[52:55] offset:3072
    ds_write_b128 v232, v[56:59] offset:4096
    ds_write_b128 v232, v[60:63] offset:5120
    ds_write_b128 v232, v[64:67] offset:6144
    ds_write_b128 v232, v[68:71] offset:7168
    s_waitcnt lgkmcnt(0)
    s_barrier
    ds_read_b128 v[72:75], v233 offset:0
    ds_read_b128 v[76:79], v233 offset:1024
    ds_read_b128 v[80:83], v233 offset:8192
    ds_read_b128 v[84:87], v233 offset:9216
    ds_read_b128 v[88:91], v233 offset:16384
    ds_read_b128 v[92:95], v233 offset:17408
    ds_read_b128 v[96:99], v233 offset:24576
    ds_read_b128 v[100:103], v233 offset:25600
    s_waitcnt lgkmcnt(4)
    v_add_f32 v72, v72, v80
    v_add_f32 v72, v72, v240
    v_add_f32 v73, v73, v81
    v_add_f32 v73, v73, v241
    v_add_f32 v74, v74, v82
    v_add_f32 v74, v74, v242
    v_add_f32 v75, v75, v83
    v_add_f32 v75, v75, v243
    v_add_f32 v76, v76, v84
    v_add_f32 v76, v76, v244
    v_add_f32 v77, v77, v85
    v_add_f32 v77, v77, v245
    v_add_f32 v78, v78, v86
    v_add_f32 v78, v78, v246
    v_add_f32 v79, v79, v87
    v_add_f32 v79, v79, v247
    s_waitcnt lgkmcnt(0)
    v_add_f32 v88, v88, v96
    v_add_f32 v88, v72, v88
    buffer_store_dword v88, v234, s[28:31], s40 offen offset:0 sc1
    v_add_f32 v89, v89, v97
    v_add_f32 v89, v73, v89
    buffer_store_dword v89, v234, s[28:31], s40 offen offset:2048 sc1
    v_add_f32 v90, v90, v98
    v_add_f32 v90, v74, v90
    buffer_store_dword v90, v235, s[28:31], s40 offen offset:0 sc1
    v_add_f32 v91, v91, v99
    v_add_f32 v91, v75, v91
    buffer_store_dword v91, v235, s[28:31], s40 offen offset:2048 sc1
    v_add_f32 v92, v92, v100
    v_add_f32 v92, v76, v92
    buffer_store_dword v92, v234, s[28:31], s41 offen offset:0 sc1
    v_add_f32 v93, v93, v101
    v_add_f32 v93, v77, v93
    buffer_store_dword v93, v234, s[28:31], s41 offen offset:2048 sc1
    v_add_f32 v94, v94, v102
    v_add_f32 v94, v78, v94
    buffer_store_dword v94, v235, s[28:31], s41 offen offset:0 sc1
    v_add_f32 v95, v95, v103
    v_add_f32 v95, v79, v95
    buffer_store_dword v95, v235, s[28:31], s41 offen offset:2048 sc1
    s_or_b32 s68, s2, s3
    s_cmp_eq_u32 s68, 0
    s_cbranch_scc0 L_noep
    s_mov_b32 s68, 14385152
    v_mov_b32 v4, s32
    s_mov_b64 exec, 1
    buffer_store_dword v4, off, s[12:15], s68 sc1
    s_mov_b64 exec, -1
L_noep:
L_end:
    s_endpgm
L_slow:
    v_lshrrev_b32 v4, 5, v0
    v_and_b32 v5, 15, v0
    v_lshlrev_b32 v5, 4, v5
    v_lshl_add_u32 v5, v4, 8, v5
    v_add_u32 v2, 4194304, v5
    v_add_u32 v1, 2097152, v3
    s_lshl_b32 s68, s46, 10
    s_add_u32 s68, s68, s76
    buffer_load_dwordx4 v[72:75], v3, s[12:15], s68 offen sc1
    v_mov_b32 v6, 0xff800000
    s_mov_b32 s73, s76
    s_mov_b32 s72, 64
L_slow1:
    buffer_load_dwordx4 v[80:83], v1, s[12:15], s73 offen sc1
    s_add_u32 s73, s73, 1024
    s_sub_u32 s72, s72, 1
    s_waitcnt vmcnt(0)
    v_mfma_f32_32x32x16_bf16 v[8:23], v[80:83], v[72:75], 0
    s_nop 11
    v_max3_f32 v6, v6, v8, v9
    v_max3_f32 v6, v6, v10, v11
    v_max3_f32 v6, v6, v12, v13
    v_max3_f32 v6, v6, v14, v15
    v_max3_f32 v6, v6, v16, v17
    v_max3_f32 v6, v6, v18, v19
    v_max3_f32 v6, v6, v20, v21
    v_max3_f32 v6, v6, v22, v23
    s_cmp_lg_u32 s72, 0
    s_cbranch_scc1 L_slow1
    v_mov_b32 v4, v6
    s_nop 1
    v_permlane32_swap_b32 v4, v6
    v_max_f32 v6, v4, v6
    v_sub_f32 v24, 0, v6
    v_sub_f32 v25, 0, v6
    v_sub_f32 v26, 0, v6
    v_sub_f32 v27, 0, v6
    v_sub_f32 v28, 0, v6
    v_sub_f32 v29, 0, v6
    v_sub_f32 v30, 0, v6
    v_sub_f32 v31, 0, v6
    v_sub_f32 v32, 0, v6
    v_sub_f32 v33, 0, v6
    v_sub_f32 v34, 0, v6
    v_sub_f32 v35, 0, v6
    v_sub_f32 v36, 0, v6
    v_sub_f32 v37, 0, v6
    v_sub_f32 v38, 0, v6
    v_sub_f32 v39, 0, v6
    v_mov_b32 v40, 0
    v_mov_b32 v41, 0
    v_mov_b32 v42, 0
    v_mov_b32 v43, 0
    v_mov_b32 v44, 0
    v_mov_b32 v45, 0
    v_mov_b32 v46, 0
    v_mov_b32 v47, 0
    v_mov_b32 v48, 0
    v_mov_b32 v49, 0
    v_mov_b32 v50, 0
    v_mov_b32 v51, 0
    v_mov_b32 v52, 0
    v_mov_b32 v53, 0
    v_mov_b32 v54, 0
    v_mov_b32 v55, 0
    s_mov_b32 s73, s76
    s_mov_b32 s72, 64
L_slow2:
    buffer_load_dwordx4 v[80:83], v1, s[12:15], s73 offen sc1
    s_mov_b64 exec, s[44:45]
    buffer_load_dwordx4 v[88:91], v2, s[12:15], s73 offen offset:0 sc1
    buffer_load_dwordx4 v[92:95], v2, s[12:15], s73 offen offset:512 sc1
    s_mov_b64 exec, -1
    s_add_u32 s73, s73, 1024
    s_sub_u32 s72, s72, 1
    s_waitcnt vmcnt(0)
    v_mfma_f32_32x32x16_bf16 v[8:23], v[80:83], v[72:75], v[24:39]
    s_nop 11
    v_exp_f32 v8, v8
    v_exp_f32 v9, v9
    v_exp_f32 v10, v10
    v_exp_f32 v11, v11
    v_exp_f32 v12, v12
    v_exp_f32 v13, v13
    v_exp_f32 v14, v14
    v_exp_f32 v15, v15
    v_exp_f32 v16, v16
    v_exp_f32 v17, v17
    v_exp_f32 v18, v18
    v_exp_f32 v19, v19
    v_exp_f32 v20, v20
    v_exp_f32 v21, v21
    v_exp_f32 v22, v22
    v_exp_f32 v23, v23
    v_smfmac_f32_32x32x32_bf16 v[40:55], v[88:91], v[8:15], v7
    s_nop 0
    v_smfmac_f32_32x32x32_bf16 v[40:55], v[92:95], v[16:23], v7
    s_cmp_lg_u32 s72, 0
    s_cbranch_scc1 L_slow2
    s_mov_b32 s47, s62
    s_mov_b32 s64, s63
    s_mov_b32 s65, s75
    buffer_load_dwordx4 v[8:11], v3, s[12:15], s47 offen offset:0 sc1
    buffer_load_dwordx4 v[12:15], v3, s[12:15], s64 offen offset:0 sc1
    buffer_load_dwordx4 v[16:19], v3, s[12:15], s65 offen offset:0 sc1
    buffer_load_dwordx4 v[20:23], v3, s[12:15], s47 offen offset:1024 sc1
    buffer_load_dwordx4 v[24:27], v3, s[12:15], s64 offen offset:1024 sc1
    buffer_load_dwordx4 v[28:31], v3, s[12:15], s65 offen offset:1024 sc1
    buffer_load_dwordx4 v[72:75], v3, s[12:15], s47 offen offset:2048 sc1
    buffer_load_dwordx4 v[76:79], v3, s[12:15], s64 offen offset:2048 sc1
    buffer_load_dwordx4 v[80:83], v3, s[12:15], s65 offen offset:2048 sc1
    buffer_load_dwordx4 v[56:59], v3, s[12:15], s47 offen offset:3072 sc1
    buffer_load_dwordx4 v[60:63], v3, s[12:15], s64 offen offset:3072 sc1
    buffer_load_dwordx4 v[64:67], v3, s[12:15], s65 offen offset:3072 sc1
    s_add_u32 s47, s47, 4096
    s_add_u32 s64, s64, 4096
    s_add_u32 s65, s65, 4096
    s_waitcnt vmcnt(0)
    s_nop 11
    s_branch L_fin
L_codeend:
.section .rodata,"a"
.p2align 6
.amdhsa_kernel gated_mix__ssm_conv_s5__softmax_full_mha__prompt_kernel
  .amdhsa_next_free_vgpr 254
  .amdhsa_next_free_sgpr 82
  .amdhsa_accum_offset 256
  .amdhsa_group_segment_fixed_size 0
  .amdhsa_kernarg_size 128
  .amdhsa_user_sgpr_count 2
  .amdhsa_user_sgpr_kernarg_segment_ptr 1
  .amdhsa_system_sgpr_workgroup_id_x 1
.end_amdhsa_kernel
```
